```python
import torch

def _softmax(x, axis=-1):
    return torch.softmax(x, dim=axis)
def _gelu(x):
    return torch.nn.functional.gelu(x, approximate="tanh")
def _silu(x):
    return torch.nn.functional.silu(x)
def _sigmoid(x):
    return torch.sigmoid(x)
def _layernorm(x, axis=-1, eps=1e-5):
    m = x.mean(dim=axis, keepdim=True)
    v = x.var(dim=axis, keepdim=True, unbiased=False)
    return (x - m) / torch.sqrt(v + eps)
def _scatter_add(tgt, idx, src, axis=0):
    return tgt.clone().index_add_(axis, idx, src)
def _segment_sum(src, seg, n):
    out = torch.zeros((n,) + src.shape[1:], dtype=src.dtype)
    return out.index_add_(0, seg, src)
def _pad(x, pw):
    flat = tuple(v for pair in reversed(pw) for v in pair)
    return torch.nn.functional.pad(x, flat)

kernel_name = 'concat_heads__gqa_block_cached__mha_block_cached__near_ridge'

def setup_inputs():

    _w = (lambda a: (lambda t: t.to(torch.bfloat16) if t.is_floating_point() else t)(torch.as_tensor(a)))
    def _A_setup():
        B, Sq, D = 8, 144, 512
        Hq, Hkv, Sk, Dh = 32, 32, 512, 128
        assert Hq % Hkv == 0, (Hq, Hkv)
        return {
            "x": _w((lambda *s: torch.randn(*s, dtype=torch.bfloat16) * 0.8)(B, Sq, D)),
            "k_cache": _w((lambda *s: torch.randn(*s, dtype=torch.bfloat16) * 0.8)(B, Hkv, Sk, Dh)),
            "v_cache": _w((lambda *s: torch.randn(*s, dtype=torch.bfloat16) * 0.05)(B, Hkv, Sk, Dh)),
            "wq": _w((lambda *s: torch.randn(*s, dtype=torch.bfloat16) * 0.8)(D, Hq * Dh) * (D ** -0.5)),
            "wo": _w((lambda *s: torch.randn(*s, dtype=torch.bfloat16) * 0.05)(Hq * Dh, D) * ((Hq * Dh) ** -0.5)),
        }
    _A_in = _A_setup()

    def _B_setup():
        B, Sq, D = 8, 144, 512
        H, Sk, Dh = 32, 512, 128
        return {
            "x": _w((lambda *s: torch.randn(*s, dtype=torch.bfloat16) * 0.8)(B, Sq, D)),
            "k_cache": _w((lambda *s: torch.randn(*s, dtype=torch.bfloat16) * 0.8)(B, H, Sk, Dh)),
            "v_cache": _w((lambda *s: torch.randn(*s, dtype=torch.bfloat16) * 0.05)(B, H, Sk, Dh)),
            "wq": _w((lambda *s: torch.randn(*s, dtype=torch.bfloat16) * 0.8)(D, H * Dh) * (D ** -0.5)),
            "wo": _w((lambda *s: torch.randn(*s, dtype=torch.bfloat16) * 0.05)(H * Dh, D) * ((H * Dh) ** -0.5)),
        }
    _B_in = _B_setup()

    return {
        "A_x": _A_in["x"],
        "A_k_cache": _A_in["k_cache"],
        "A_v_cache": _A_in["v_cache"],
        "A_wq": _A_in["wq"],
        "A_wo": _A_in["wo"],
        "B_x": _B_in["x"],
        "B_k_cache": _B_in["k_cache"],
        "B_v_cache": _B_in["v_cache"],
        "B_wq": _B_in["wq"],
        "B_wo": _B_in["wo"],
    }

def reference(A_x, A_k_cache, A_v_cache, A_wq, A_wo, B_x, B_k_cache, B_v_cache, B_wq, B_wo):
    def _A_ref(x, k_cache, v_cache, wq, wo):
        B, Sq, D = x.shape
        Hq, Dh = 32, 128
        Hkv = k_cache.shape[1]
        rep = Hq // Hkv
        q = (lambda x, *d: x.permute(*d))((x @ wq).reshape(B, Sq, Hq, Dh), 0, 2, 1, 3)
        k = (lambda x, n, axis: torch.repeat_interleave(x, n, dim=axis))(k_cache, rep, axis=1)
        v = (lambda x, n, axis: torch.repeat_interleave(x, n, dim=axis))(v_cache, rep, axis=1)
        scores = torch.einsum("bhqd,bhkd->bhqk", q, k) * (Dh ** -0.5)
        p = _softmax(scores, axis=-1)
        o = torch.einsum("bhqk,bhkd->bhqd", p, v)
        return (lambda x, *d: x.permute(*d))(o, 0, 2, 1, 3).reshape(B, Sq, Hq * Dh) @ wo

    def _B_ref(x, k_cache, v_cache, wq, wo):
        B, Sq, D = x.shape
        H, Dh = 32, 128
        q = (lambda x, *d: x.permute(*d))((x @ wq).reshape(B, Sq, H, Dh), 0, 2, 1, 3)
        scores = torch.einsum("bhqd,bhkd->bhqk", q, k_cache) * (Dh ** -0.5)
        p = _softmax(scores, axis=-1)
        o = torch.einsum("bhqk,bhkd->bhqd", p, v_cache)
        return (lambda x, *d: x.permute(*d))(o, 0, 2, 1, 3).reshape(B, Sq, H * Dh) @ wo

    a = _A_ref(A_x, A_k_cache, A_v_cache, A_wq, A_wo)
    b = _B_ref(B_x, B_k_cache, B_v_cache, B_wq, B_wo)
    return torch.concatenate([a, b], axis=-1)
```

```asm
; @launch grid=(256,1,1) block=(256,1,1) lds=163840
.amdgcn_target "amdgcn-amd-amdhsa--gfx950"
.text
.globl concat_heads__gqa_block_cached__mha_block_cached__near_ridge_kernel
.p2align 8
.type concat_heads__gqa_block_cached__mha_block_cached__near_ridge_kernel,@function
concat_heads__gqa_block_cached__mha_block_cached__near_ridge_kernel:
  s_cmp_ge_u32 s2, 256
  s_cbranch_scc1 concat_heads__gqa_block_cached__mha_block_cached__near_ridge_kernel_done
  s_load_dwordx8 s[36:43], s[0:1], 0
  s_load_dwordx8 s[44:51], s[0:1], 40
  s_load_dwordx2 s[54:55], s[0:1], 96
  s_load_dwordx2 s[98:99], s[0:1], 32
  s_load_dwordx2 s[100:101], s[0:1], 72
  s_load_dwordx4 s[84:87], s[0:1], 80
  s_getpc_b64 s[90:91]
concat_heads__gqa_block_cached__mha_block_cached__near_ridge_kernel_pc:
  s_lshr_b32 s92, s2, 3
  s_lshl_b32 s92, s92, 12
  v_lshlrev_b32 v28, 4, v0
  v_add_u32 v28, s92, v28
  v_and_b32 v28, 0x7fff, v28
  v_min_u32 v28, concat_heads__gqa_block_cached__mha_block_cached__near_ridge_kernel_done-concat_heads__gqa_block_cached__mha_block_cached__near_ridge_kernel_pc-16, v28
  global_load_dwordx4 v[252:255], v28, s[90:91]
  v_lshrrev_b32 v27, 6, v0
  v_and_b32 v0, 63, v0
  v_readfirstlane_b32 s3, v27
  s_and_b32 s52, s2, 7
  s_lshr_b32 s27, s52, 2
  s_lshr_b32 s28, s2, 5
  s_bfe_u32 s53, s2, 0x20003
  s_and_b32 s52, s52, 3
  s_lshl_b32 s29, s52, 3
  s_lshl_b32 s56, s53, 1
  s_add_u32 s29, s29, s56
  s_mov_b32 s56, s28
  s_add_u32 s26, s56, s53
  s_and_b32 s26, s26, 3
  s_lshl_b32 s26, s26, 2
  s_and_b32 s24, s3, 1
  s_lshr_b32 s25, s3, 1
  v_lshrrev_b32 v27, 5, v0
  s_lshl_b32 s52, s3, 3
  v_add_u32 v27, s52, v27
  v_and_b32 v30, 31, v0
  v_add_u32 v28, 0, v27
  v_and_b32 v29, 3, v28
  v_lshlrev_b32 v29, 2, v29
  v_xor_b32 v29, v29, v30
  v_lshlrev_b32 v29, 4, v29
  v_lshl_add_u32 v205, v28, 13, v29
  v_add_u32 v28, 2, v27
  v_and_b32 v29, 3, v28
  v_lshlrev_b32 v29, 2, v29
  v_xor_b32 v29, v29, v30
  v_lshlrev_b32 v29, 4, v29
  v_lshl_add_u32 v206, v28, 13, v29
  v_subrev_u32 v206, 1024, v206
  v_add_u32 v28, 4, v27
  v_and_b32 v29, 3, v28
  v_lshlrev_b32 v29, 2, v29
  v_xor_b32 v29, v29, v30
  v_lshlrev_b32 v29, 4, v29
  v_lshl_add_u32 v207, v28, 13, v29
  v_subrev_u32 v207, 2048, v207
  v_add_u32 v28, 6, v27
  v_and_b32 v29, 3, v28
  v_lshlrev_b32 v29, 2, v29
  v_xor_b32 v29, v29, v30
  v_lshlrev_b32 v29, 4, v29
  v_lshl_add_u32 v208, v28, 13, v29
  v_subrev_u32 v208, 3072, v208
  s_mul_i32 s52, s3, 5
  s_cmp_eq_u32 s3, 3
  s_cselect_b32 s53, 1, 0
  s_sub_u32 s52, s52, s53
  s_lshl_b32 s57, s52, 10
  s_lshl_b32 s52, s52, 3
  v_lshrrev_b32 v27, 3, v0
  v_add_u32 v27, s52, v27
  v_and_b32 v30, 7, v0
  v_add_u32 v28, 0, v27
  v_lshrrev_b32 v29, 1, v28
  v_and_b32 v29, 7, v29
  v_xor_b32 v29, v29, v30
  v_lshlrev_b32 v29, 4, v29
  v_lshl_add_u32 v200, v28, 10, v29
  v_add_u32 v28, 8, v27
  v_lshrrev_b32 v29, 1, v28
  v_and_b32 v29, 7, v29
  v_xor_b32 v29, v29, v30
  v_lshlrev_b32 v29, 4, v29
  v_lshl_add_u32 v201, v28, 10, v29
  v_subrev_u32 v201, 1024, v201
  v_add_u32 v28, 16, v27
  v_lshrrev_b32 v29, 1, v28
  v_and_b32 v29, 7, v29
  v_xor_b32 v29, v29, v30
  v_lshlrev_b32 v29, 4, v29
  v_lshl_add_u32 v202, v28, 10, v29
  v_subrev_u32 v202, 2048, v202
  v_add_u32 v28, 24, v27
  v_lshrrev_b32 v29, 1, v28
  v_and_b32 v29, 7, v29
  v_xor_b32 v29, v29, v30
  v_lshlrev_b32 v29, 4, v29
  v_lshl_add_u32 v203, v28, 10, v29
  v_subrev_u32 v203, 3072, v203
  v_add_u32 v28, 32, v27
  v_lshrrev_b32 v29, 1, v28
  v_and_b32 v29, 7, v29
  v_xor_b32 v29, v29, v30
  v_lshlrev_b32 v29, 4, v29
  v_lshl_add_u32 v204, v28, 10, v29
  s_cmp_lt_u32 s3, 2
  s_cselect_b64 vcc, -1, 0
  s_waitcnt lgkmcnt(0)
  s_cmp_eq_u32 s27, 0
  s_cselect_b32 s4, s36, s44
  s_cselect_b32 s5, s37, s45
  s_cselect_b32 s12, s38, s46
  s_cselect_b32 s13, s39, s47
  s_cselect_b32 s16, s40, s48
  s_cselect_b32 s17, s41, s49
  s_cselect_b32 s8, s42, s50
  s_cselect_b32 s9, s43, s51
  s_cselect_b32 s98, s98, s100
  s_cselect_b32 s99, s99, s101
  s_lshl_b32 s39, s3, 11
  s_lshl_b32 s40, s25, 12
  s_mul_i32 s52, s28, 147456
  s_add_u32 s4, s4, s52
  s_addc_u32 s5, s5, 0
  s_mov_b32 s6, 147456
  s_mov_b32 s7, 0x20000
  s_lshl_b32 s52, s29, 8
  s_add_u32 s8, s8, s52
  s_addc_u32 s9, s9, 0
  s_sub_u32 s10, 0x400000, s52
  s_mov_b32 s11, 0x20000
  s_lshl_b32 s38, s3, 12
  s_mov_b32 s45, s57
  s_lshl_b32 s46, s26, 6
  s_lshl_b32 s44, s26, 18
  s_add_u32 m0, s45, 0
  s_nop 0
  buffer_load_dwordx4 v200, s[4:7], s46 offen  lds
  buffer_load_dwordx4 v201, s[4:7], s46 offen offset:1024  lds
  buffer_load_dwordx4 v202, s[4:7], s46 offen offset:2048  lds
  buffer_load_dwordx4 v203, s[4:7], s46 offen offset:3072  lds
  s_cbranch_vccz concat_heads__gqa_block_cached__mha_block_cached__near_ridge_kernel_x51
  s_add_u32 m0, s45, 4096
  s_nop 0
  buffer_load_dwordx4 v204, s[4:7], s46 offen  lds
concat_heads__gqa_block_cached__mha_block_cached__near_ridge_kernel_x51:
  s_add_u32 s46, s46, 128
  s_and_b32 s46, s46, 1023
  s_add_u32 m0, s38, 36864
  s_nop 0
  buffer_load_dwordx4 v205, s[8:11], s44 offen  lds
  buffer_load_dwordx4 v206, s[8:11], s44 offen offset:1024  lds
  buffer_load_dwordx4 v207, s[8:11], s44 offen offset:2048  lds
  buffer_load_dwordx4 v208, s[8:11], s44 offen offset:3072  lds
  s_add_u32 s44, s44, 0x40000
  s_and_b32 s44, s44, 0x3fffff
  s_lshl_b32 s52, s28, 5
  s_add_u32 s52, s52, s29
  s_lshr_b32 s53, s52, 15
  s_lshl_b32 s52, s52, 17
  s_add_u32 s12, s12, s52
  s_addc_u32 s13, s13, s53
  s_mov_b32 s14, 262144
  s_mov_b32 s15, 0x20000
  s_add_u32 s16, s16, s52
  s_addc_u32 s17, s17, s53
  s_mov_b32 s18, 262144
  s_mov_b32 s19, 0x20000
  s_lshl_b32 s52, s27, 3
  s_add_u32 s52, s52, s28
  s_mul_i32 s52, s52, 1179648
  s_add_u32 s20, s54, s52
  s_addc_u32 s21, s55, 0
  s_mov_b32 s22, 1179648
  s_mov_b32 s23, 0x20000
  v_lshrrev_b32 v27, 4, v0
  s_lshl_b32 s52, s24, 3
  v_add_u32 v27, s52, v27
  v_and_b32 v30, 15, v0
  v_add_u32 v29, 0, v27
  v_xor_b32 v31, v29, v30
  v_lshlrev_b32 v31, 4, v31
  v_lshl_add_u32 v1, v27, 8, v31
  v_and_b32 v29, 7, v29
  v_lshlrev_b32 v29, 1, v29
  v_xor_b32 v31, v29, v30
  v_lshlrev_b32 v31, 4, v31
  v_lshl_add_u32 v3, v27, 8, v31
  v_add_u32 v29, 4, v27
  v_xor_b32 v31, v29, v30
  v_lshlrev_b32 v31, 4, v31
  v_lshl_add_u32 v2, v27, 8, v31
  v_and_b32 v29, 7, v29
  v_lshlrev_b32 v29, 1, v29
  v_xor_b32 v31, v29, v30
  v_lshlrev_b32 v31, 4, v31
  v_lshl_add_u32 v4, v27, 8, v31
  v_and_b32 v27, 15, v0
  v_lshrrev_b32 v28, 4, v0
  v_lshrrev_b32 v29, 1, v27
  v_xor_b32 v29, v29, v28
  s_lshl_b32 s52, s24, 13
  v_lshlrev_b32 v30, 7, v27
  v_add_u32 v30, s52, v30
  v_xor_b32 v31, 0, v29
  v_lshl_add_u32 v19, v31, 4, v30
  v_xor_b32 v31, 4, v29
  v_lshl_add_u32 v20, v31, 4, v30
  s_sub_u32 s52, 16384, s52
  v_add_u32 v21, s52, v19
  v_add_u32 v22, s52, v20
  v_bfe_u32 v29, v0, 2, 2
  v_lshl_add_u32 v30, v28, 3, v29
  v_lshlrev_b32 v30, 9, v30
  v_add_u32 v30, 36864, v30
  v_lshlrev_b32 v29, 2, v29
  v_and_b32 v31, 3, v0
  v_xor_b32 v29, v29, v31
  s_lshl_b32 s52, s25, 4
  s_lshl_b32 s53, s24, 3
  s_or_b32 s52, s52, s53
  v_xor_b32 v29, s52, v29
  v_xor_b32 v31, 0, v29
  v_lshl_add_u32 v23, v31, 4, v30
  v_xor_b32 v31, 4, v29
  v_lshl_add_u32 v24, v31, 4, v30
  v_xor_b32 v31, 8, v29
  v_lshl_add_u32 v25, v31, 4, v30
  v_xor_b32 v31, 12, v29
  v_lshl_add_u32 v26, v31, 4, v30
  v_xor_b32 v29, v27, v28
  s_lshl_b32 s53, s24, 3
  v_xor_b32 v29, s53, v29
  s_lshl_b32 s52, s25, 13
  s_add_u32 s52, s52, 98304
  v_lshlrev_b32 v30, 8, v27
  v_add_u32 v30, s52, v30
  v_xor_b32 v31, 0, v29
  v_lshl_add_u32 v5, v31, 4, v30
  v_xor_b32 v31, 4, v29
  v_lshl_add_u32 v6, v31, 4, v30
  v_xor_b32 v31, 8, v29
  v_lshl_add_u32 v7, v31, 4, v30
  v_xor_b32 v31, 12, v29
  v_lshl_add_u32 v8, v31, 4, v30
  v_bfe_u32 v29, v0, 2, 2
  v_lshl_add_u32 v29, v28, 2, v29
  v_lshlrev_b32 v30, 8, v29
  v_and_b32 v31, 1, v0
  v_lshl_add_u32 v30, v31, 3, v30
  s_lshl_b32 s52, s25, 13
  s_add_u32 s52, s52, 114688
  v_add_u32 v30, s52, v30
  v_and_b32 v29, 7, v29
  v_lshlrev_b32 v29, 1, v29
  v_bfe_u32 v31, v0, 1, 1
  v_xor_b32 v29, v29, v31
  s_lshl_b32 s53, s24, 3
  v_xor_b32 v29, s53, v29
  v_xor_b32 v31, 0, v29
  v_lshl_add_u32 v9, v31, 4, v30
  v_xor_b32 v31, 2, v29
  v_lshl_add_u32 v10, v31, 4, v30
  v_xor_b32 v31, 4, v29
  v_lshl_add_u32 v11, v31, 4, v30
  v_xor_b32 v31, 6, v29
  v_lshl_add_u32 v12, v31, 4, v30
  v_xor_b32 v31, 8, v29
  v_lshl_add_u32 v13, v31, 4, v30
  v_xor_b32 v31, 10, v29
  v_lshl_add_u32 v14, v31, 4, v30
  v_xor_b32 v31, 12, v29
  v_lshl_add_u32 v15, v31, 4, v30
  v_xor_b32 v31, 14, v29
  v_lshl_add_u32 v16, v31, 4, v30
  v_mov_b32 v32, 0
  v_mov_b32 v33, 0
  v_mov_b32 v34, 0
  v_mov_b32 v35, 0
  v_mov_b32 v36, 0
  v_mov_b32 v37, 0
  v_mov_b32 v38, 0
  v_mov_b32 v39, 0
  v_mov_b32 v40, 0
  v_mov_b32 v41, 0
  v_mov_b32 v42, 0
  v_mov_b32 v43, 0
  v_mov_b32 v44, 0
  v_mov_b32 v45, 0
  v_mov_b32 v46, 0
  v_mov_b32 v47, 0
  v_mov_b32 v48, 0
  v_mov_b32 v49, 0
  v_mov_b32 v50, 0
  v_mov_b32 v51, 0
  v_mov_b32 v52, 0
  v_mov_b32 v53, 0
  v_mov_b32 v54, 0
  v_mov_b32 v55, 0
  v_mov_b32 v56, 0
  v_mov_b32 v57, 0
  v_mov_b32 v58, 0
  v_mov_b32 v59, 0
  v_mov_b32 v60, 0
  v_mov_b32 v61, 0
  v_mov_b32 v62, 0
  v_mov_b32 v63, 0
  v_mov_b32 v64, 0
  v_mov_b32 v65, 0
  v_mov_b32 v66, 0
  v_mov_b32 v67, 0
  v_mov_b32 v68, 0
  v_mov_b32 v69, 0
  v_mov_b32 v70, 0
  v_mov_b32 v71, 0
  v_mov_b32 v72, 0
  v_mov_b32 v73, 0
  v_mov_b32 v74, 0
  v_mov_b32 v75, 0
  v_mov_b32 v76, 0
  v_mov_b32 v77, 0
  v_mov_b32 v78, 0
  v_mov_b32 v79, 0
  v_mov_b32 v80, 0
  v_mov_b32 v81, 0
  v_mov_b32 v82, 0
  v_mov_b32 v83, 0
  v_mov_b32 v84, 0
  v_mov_b32 v85, 0
  v_mov_b32 v86, 0
  v_mov_b32 v87, 0
  v_mov_b32 v88, 0
  v_mov_b32 v89, 0
  v_mov_b32 v90, 0
  v_mov_b32 v91, 0
  v_mov_b32 v92, 0
  v_mov_b32 v93, 0
  v_mov_b32 v94, 0
  v_mov_b32 v95, 0
  v_mov_b32 v96, 0
  v_mov_b32 v97, 0
  v_mov_b32 v98, 0
  v_mov_b32 v99, 0
  v_mov_b32 v100, 0
  v_mov_b32 v101, 0
  v_mov_b32 v102, 0
  v_mov_b32 v103, 0
  v_mov_b32 v104, 0
  v_mov_b32 v105, 0
  v_mov_b32 v106, 0
  v_mov_b32 v107, 0
  v_mov_b32 v108, 0
  v_mov_b32 v109, 0
  v_mov_b32 v110, 0
  v_mov_b32 v111, 0
  v_mov_b32 v112, 0
  v_mov_b32 v113, 0
  v_mov_b32 v114, 0
  v_mov_b32 v115, 0
  v_mov_b32 v116, 0
  v_mov_b32 v117, 0
  v_mov_b32 v118, 0
  v_mov_b32 v119, 0
  v_mov_b32 v120, 0
  v_mov_b32 v121, 0
  v_mov_b32 v122, 0
  v_mov_b32 v123, 0
  v_mov_b32 v124, 0
  v_mov_b32 v125, 0
  v_mov_b32 v126, 0
  v_mov_b32 v127, 0
  v_mov_b32 v128, 0
  v_mov_b32 v129, 0
  v_mov_b32 v130, 0
  v_mov_b32 v131, 0
  v_mov_b32 v132, 0
  v_mov_b32 v133, 0
  v_mov_b32 v134, 0
  v_mov_b32 v135, 0
  v_mov_b32 v136, 0
  v_mov_b32 v137, 0
  v_mov_b32 v138, 0
  v_mov_b32 v139, 0
  v_mov_b32 v140, 0
  v_mov_b32 v141, 0
  v_mov_b32 v142, 0
  v_mov_b32 v143, 0
  v_mov_b32 v144, 0
  v_mov_b32 v145, 0
  v_mov_b32 v146, 0
  v_mov_b32 v147, 0
  v_mov_b32 v148, 0
  v_mov_b32 v149, 0
  v_mov_b32 v150, 0
  v_mov_b32 v151, 0
  v_mov_b32 v152, 0
  v_mov_b32 v153, 0
  v_mov_b32 v154, 0
  v_mov_b32 v155, 0
  v_mov_b32 v156, 0
  v_mov_b32 v157, 0
  v_mov_b32 v158, 0
  v_mov_b32 v159, 0
  v_mov_b32 v160, 0
  v_mov_b32 v161, 0
  v_mov_b32 v162, 0
  v_mov_b32 v163, 0
  v_mov_b32 v164, 0
  v_mov_b32 v165, 0
  v_mov_b32 v166, 0
  v_mov_b32 v167, 0
  v_mov_b32 v168, 0
  v_mov_b32 v169, 0
  v_mov_b32 v170, 0
  v_mov_b32 v171, 0
  v_mov_b32 v172, 0
  v_mov_b32 v173, 0
  v_mov_b32 v174, 0
  v_mov_b32 v175, 0
  s_add_u32 m0, s38, 53248
  s_nop 0
  buffer_load_dwordx4 v205, s[8:11], s44 offen  lds
  buffer_load_dwordx4 v206, s[8:11], s44 offen offset:1024  lds
  buffer_load_dwordx4 v207, s[8:11], s44 offen offset:2048  lds
  buffer_load_dwordx4 v208, s[8:11], s44 offen offset:3072  lds
  s_add_u32 s44, s44, 0x40000
  s_and_b32 s44, s44, 0x3fffff
  s_waitcnt vmcnt(4)
  s_barrier
  ds_read_b64_tr_b16 a[128:129], v23 offset:0
  ds_read_b64_tr_b16 a[130:131], v23 offset:2048
  ds_read_b64_tr_b16 a[132:133], v23 offset:8
  ds_read_b64_tr_b16 a[134:135], v23 offset:2056
  ds_read_b64_tr_b16 a[136:137], v24 offset:0
  ds_read_b64_tr_b16 a[138:139], v24 offset:2048
  ds_read_b64_tr_b16 a[140:141], v24 offset:8
  ds_read_b64_tr_b16 a[142:143], v24 offset:2056
  ds_read_b64_tr_b16 a[144:145], v25 offset:0
  ds_read_b64_tr_b16 a[146:147], v25 offset:2048
  ds_read_b64_tr_b16 a[148:149], v25 offset:8
  ds_read_b64_tr_b16 a[150:151], v25 offset:2056
  ds_read_b64_tr_b16 a[152:153], v26 offset:0
  ds_read_b64_tr_b16 a[154:155], v26 offset:2048
  ds_read_b64_tr_b16 a[156:157], v26 offset:8
  s_waitcnt lgkmcnt(7)
  ds_read_b64_tr_b16 a[158:159], v26 offset:2056
  ds_read_b128 a[160:163], v19 offset:0
  ds_read_b128 a[164:167], v19 offset:2048
  ds_read_b128 a[168:171], v19 offset:4096
  ds_read_b128 a[172:175], v19 offset:6144
  ds_read_b128 a[176:179], v21 offset:0
  s_add_u32 m0, s45, 18432
  s_nop 0
  buffer_load_dwordx4 v200, s[4:7], s46 offen  lds
  buffer_load_dwordx4 v201, s[4:7], s46 offen offset:1024  lds
  buffer_load_dwordx4 v202, s[4:7], s46 offen offset:2048  lds
  buffer_load_dwordx4 v203, s[4:7], s46 offen offset:3072  lds
  s_cbranch_vccz concat_heads__gqa_block_cached__mha_block_cached__near_ridge_kernel_x52
  s_add_u32 m0, s45, 22528
  s_nop 0
  buffer_load_dwordx4 v204, s[4:7], s46 offen  lds
concat_heads__gqa_block_cached__mha_block_cached__near_ridge_kernel_x52:
  s_add_u32 s46, s46, 128
  s_and_b32 s46, s46, 1023
  s_add_u32 m0, s38, 69632
  s_nop 0
  buffer_load_dwordx4 v205, s[8:11], s44 offen  lds
  buffer_load_dwordx4 v206, s[8:11], s44 offen offset:1024  lds
  buffer_load_dwordx4 v207, s[8:11], s44 offen offset:2048  lds
  buffer_load_dwordx4 v208, s[8:11], s44 offen offset:3072  lds
  s_add_u32 s44, s44, 0x40000
  s_and_b32 s44, s44, 0x3fffff
  s_add_u32 m0, s38, 86016
  s_nop 0
  buffer_load_dwordx4 v205, s[8:11], s44 offen  lds
  buffer_load_dwordx4 v206, s[8:11], s44 offen offset:1024  lds
  buffer_load_dwordx4 v207, s[8:11], s44 offen offset:2048  lds
  buffer_load_dwordx4 v208, s[8:11], s44 offen offset:3072  lds
  s_add_u32 s44, s44, 0x40000
  s_and_b32 s44, s44, 0x3fffff
  s_mov_b32 s30, 0
concat_heads__gqa_block_cached__mha_block_cached__near_ridge_kernel_qloop:
  s_cmp_eq_u32 s30, 0
  s_cbranch_scc0 concat_heads__gqa_block_cached__mha_block_cached__near_ridge_kernel_q243
  s_waitcnt vmcnt(12)
  s_branch concat_heads__gqa_block_cached__mha_block_cached__near_ridge_kernel_qd4
concat_heads__gqa_block_cached__mha_block_cached__near_ridge_kernel_q243:
  s_waitcnt vmcnt(24)
concat_heads__gqa_block_cached__mha_block_cached__near_ridge_kernel_qd4:
  s_waitcnt lgkmcnt(0)
  s_barrier
  v_mfma_f32_16x16x32_bf16 v[32:35], a[128:131], a[160:163], v[32:35]
  v_mfma_f32_16x16x32_bf16 v[36:39], a[128:131], a[164:167], v[36:39]
  ds_read_b64_tr_b16 a[180:181], v23 offset:16384
  v_mfma_f32_16x16x32_bf16 v[40:43], a[128:131], a[168:171], v[40:43]
  ds_read_b64_tr_b16 a[182:183], v23 offset:18432
  v_mfma_f32_16x16x32_bf16 v[44:47], a[128:131], a[172:175], v[44:47]
  ds_read_b64_tr_b16 a[184:185], v23 offset:16392
  v_mfma_f32_16x16x32_bf16 v[160:163], a[128:131], a[176:179], v[160:163]
  s_add_u32 m0, s38, 36864
  s_nop 0
  buffer_load_dwordx4 v205, s[8:11], s44 offen  lds
  v_mfma_f32_16x16x32_bf16 v[48:51], a[132:135], a[160:163], v[48:51]
  ds_read_b64_tr_b16 a[186:187], v23 offset:18440
  v_mfma_f32_16x16x32_bf16 v[52:55], a[132:135], a[164:167], v[52:55]
  ds_read_b64_tr_b16 a[188:189], v24 offset:16384
  v_mfma_f32_16x16x32_bf16 v[56:59], a[132:135], a[168:171], v[56:59]
  ds_read_b64_tr_b16 a[190:191], v24 offset:18432
  v_mfma_f32_16x16x32_bf16 v[60:63], a[132:135], a[172:175], v[60:63]
  ds_read_b64_tr_b16 a[192:193], v24 offset:16392
  v_mfma_f32_16x16x32_bf16 v[164:167], a[132:135], a[176:179], v[164:167]
  ds_read_b64_tr_b16 a[194:195], v24 offset:18440
  v_mfma_f32_16x16x32_bf16 v[64:67], a[136:139], a[160:163], v[64:67]
  buffer_load_dwordx4 v206, s[8:11], s44 offen offset:1024  lds
  v_mfma_f32_16x16x32_bf16 v[68:71], a[136:139], a[164:167], v[68:71]
  ds_read_b64_tr_b16 a[196:197], v25 offset:16384
  v_mfma_f32_16x16x32_bf16 v[72:75], a[136:139], a[168:171], v[72:75]
  ds_read_b64_tr_b16 a[198:199], v25 offset:18432
  v_mfma_f32_16x16x32_bf16 v[76:79], a[136:139], a[172:175], v[76:79]
  v_mfma_f32_16x16x32_bf16 v[168:171], a[136:139], a[176:179], v[168:171]
  ds_read_b64_tr_b16 a[200:201], v25 offset:16392
  v_mfma_f32_16x16x32_bf16 v[80:83], a[140:143], a[160:163], v[80:83]
  ds_read_b64_tr_b16 a[202:203], v25 offset:18440
  v_mfma_f32_16x16x32_bf16 v[84:87], a[140:143], a[164:167], v[84:87]
  ds_read_b64_tr_b16 a[204:205], v26 offset:16384
  v_mfma_f32_16x16x32_bf16 v[88:91], a[140:143], a[168:171], v[88:91]
  buffer_load_dwordx4 v207, s[8:11], s44 offen offset:2048  lds
  v_mfma_f32_16x16x32_bf16 v[92:95], a[140:143], a[172:175], v[92:95]
  ds_read_b64_tr_b16 a[206:207], v26 offset:18432
  v_mfma_f32_16x16x32_bf16 v[172:175], a[140:143], a[176:179], v[172:175]
  ds_read_b64_tr_b16 a[208:209], v26 offset:16392
  v_mfma_f32_16x16x32_bf16 v[96:99], a[144:147], a[160:163], v[96:99]
  s_waitcnt lgkmcnt(7)
  ds_read_b64_tr_b16 a[210:211], v26 offset:18440
  v_mfma_f32_16x16x32_bf16 v[100:103], a[144:147], a[164:167], v[100:103]
  ds_read_b128 a[212:215], v20 offset:0
  v_mfma_f32_16x16x32_bf16 v[104:107], a[144:147], a[168:171], v[104:107]
  ds_read_b128 a[216:219], v20 offset:2048
  v_mfma_f32_16x16x32_bf16 v[108:111], a[144:147], a[172:175], v[108:111]
  buffer_load_dwordx4 v208, s[8:11], s44 offen offset:3072  lds
  s_add_u32 s44, s44, 0x40000
  s_and_b32 s44, s44, 0x3fffff
  v_mfma_f32_16x16x32_bf16 v[112:115], a[148:151], a[160:163], v[112:115]
  ds_read_b128 a[220:223], v20 offset:4096
  v_mfma_f32_16x16x32_bf16 v[116:119], a[148:151], a[164:167], v[116:119]
  ds_read_b128 a[224:227], v20 offset:6144
  v_mfma_f32_16x16x32_bf16 v[120:123], a[148:151], a[168:171], v[120:123]
  ds_read_b128 a[228:231], v22 offset:0
  v_mfma_f32_16x16x32_bf16 v[124:127], a[148:151], a[172:175], v[124:127]
  v_mfma_f32_16x16x32_bf16 v[128:131], a[152:155], a[160:163], v[128:131]
  v_mfma_f32_16x16x32_bf16 v[132:135], a[152:155], a[164:167], v[132:135]
  v_mfma_f32_16x16x32_bf16 v[136:139], a[152:155], a[168:171], v[136:139]
  v_mfma_f32_16x16x32_bf16 v[140:143], a[152:155], a[172:175], v[140:143]
  v_mfma_f32_16x16x32_bf16 v[144:147], a[156:159], a[160:163], v[144:147]
  v_mfma_f32_16x16x32_bf16 v[148:151], a[156:159], a[164:167], v[148:151]
  v_mfma_f32_16x16x32_bf16 v[152:155], a[156:159], a[168:171], v[152:155]
  v_mfma_f32_16x16x32_bf16 v[156:159], a[156:159], a[172:175], v[156:159]
  s_cmp_eq_u32 s30, 1
  s_cbranch_scc1 concat_heads__gqa_block_cached__mha_block_cached__near_ridge_kernel_qv6
  s_cmp_eq_u32 s30, 2
  s_cbranch_scc1 concat_heads__gqa_block_cached__mha_block_cached__near_ridge_kernel_qv7
concat_heads__gqa_block_cached__mha_block_cached__near_ridge_kernel_qv5:
  s_waitcnt vmcnt(4) lgkmcnt(0)
  s_barrier
  v_mfma_f32_16x16x32_bf16 v[32:35], a[180:183], a[212:215], v[32:35]
  ds_read_b64_tr_b16 a[128:129], v23 offset:32768
  v_mfma_f32_16x16x32_bf16 v[36:39], a[180:183], a[216:219], v[36:39]
  s_add_u32 m0, s38, 53248
  s_nop 0
  buffer_load_dwordx4 v205, s[8:11], s44 offen  lds
  v_mfma_f32_16x16x32_bf16 v[40:43], a[180:183], a[220:223], v[40:43]
  ds_read_b64_tr_b16 a[130:131], v23 offset:34816
  buffer_load_dwordx4 v206, s[8:11], s44 offen offset:1024  lds
  v_mfma_f32_16x16x32_bf16 v[44:47], a[180:183], a[224:227], v[44:47]
  ds_read_b64_tr_b16 a[132:133], v23 offset:32776
  v_mfma_f32_16x16x32_bf16 v[160:163], a[180:183], a[228:231], v[160:163]
  buffer_load_dwordx4 v207, s[8:11], s44 offen offset:2048  lds
  ds_read_b64_tr_b16 a[134:135], v23 offset:34824
  v_mfma_f32_16x16x32_bf16 v[48:51], a[184:187], a[212:215], v[48:51]
  buffer_load_dwordx4 v208, s[8:11], s44 offen offset:3072  lds
  s_add_u32 s44, s44, 0x40000
  s_and_b32 s44, s44, 0x3fffff
  v_mfma_f32_16x16x32_bf16 v[52:55], a[184:187], a[216:219], v[52:55]
  ds_read_b64_tr_b16 a[136:137], v24 offset:32768
  v_mfma_f32_16x16x32_bf16 v[56:59], a[184:187], a[220:223], v[56:59]
  ds_read_b64_tr_b16 a[138:139], v24 offset:34816
  s_add_u32 m0, s45, 0
  s_nop 0
  buffer_load_dwordx4 v200, s[4:7], s46 offen  lds
  v_mfma_f32_16x16x32_bf16 v[60:63], a[184:187], a[224:227], v[60:63]
  ds_read_b64_tr_b16 a[140:141], v24 offset:32776
  v_mfma_f32_16x16x32_bf16 v[164:167], a[184:187], a[228:231], v[164:167]
  buffer_load_dwordx4 v201, s[4:7], s46 offen offset:1024  lds
  ds_read_b64_tr_b16 a[142:143], v24 offset:34824
  v_mfma_f32_16x16x32_bf16 v[64:67], a[188:191], a[212:215], v[64:67]
  buffer_load_dwordx4 v202, s[4:7], s46 offen offset:2048  lds
  v_mfma_f32_16x16x32_bf16 v[68:71], a[188:191], a[216:219], v[68:71]
  ds_read_b64_tr_b16 a[144:145], v25 offset:32768
  v_mfma_f32_16x16x32_bf16 v[72:75], a[188:191], a[220:223], v[72:75]
  buffer_load_dwordx4 v203, s[4:7], s46 offen offset:3072  lds
  ds_read_b64_tr_b16 a[146:147], v25 offset:34816
  v_mfma_f32_16x16x32_bf16 v[76:79], a[188:191], a[224:227], v[76:79]
  ds_read_b64_tr_b16 a[148:149], v25 offset:32776
  v_mfma_f32_16x16x32_bf16 v[168:171], a[188:191], a[228:231], v[168:171]
  s_cbranch_vccz concat_heads__gqa_block_cached__mha_block_cached__near_ridge_kernel_x59
  s_add_u32 m0, s45, 4096
  s_nop 0
  buffer_load_dwordx4 v204, s[4:7], s46 offen  lds
concat_heads__gqa_block_cached__mha_block_cached__near_ridge_kernel_x59:
  s_add_u32 s46, s46, 128
  s_and_b32 s46, s46, 1023
  ds_read_b64_tr_b16 a[150:151], v25 offset:34824
  v_mfma_f32_16x16x32_bf16 v[80:83], a[192:195], a[212:215], v[80:83]
  s_add_u32 s37, s40, 16384
  buffer_load_dwordx4 a[80:83], v1, s[12:15], s37 offen nt
  v_mfma_f32_16x16x32_bf16 v[84:87], a[192:195], a[216:219], v[84:87]
  ds_read_b64_tr_b16 a[152:153], v26 offset:32768
  v_mfma_f32_16x16x32_bf16 v[88:91], a[192:195], a[220:223], v[88:91]
  buffer_load_dwordx4 a[84:87], v2, s[12:15], s37 offen offset:1024 nt
  ds_read_b64_tr_b16 a[154:155], v26 offset:34816
  v_mfma_f32_16x16x32_bf16 v[92:95], a[192:195], a[224:227], v[92:95]
  s_add_u32 s37, s40, 147456
  buffer_load_dwordx4 a[88:91], v1, s[12:15], s37 offen nt
  v_mfma_f32_16x16x32_bf16 v[172:175], a[192:195], a[228:231], v[172:175]
  ds_read_b64_tr_b16 a[156:157], v26 offset:32776
  buffer_load_dwordx4 a[92:95], v2, s[12:15], s37 offen offset:1024 nt
  v_mfma_f32_16x16x32_bf16 v[96:99], a[196:199], a[212:215], v[96:99]
  s_waitcnt lgkmcnt(7)
  ds_read_b64_tr_b16 a[158:159], v26 offset:34824
  v_mfma_f32_16x16x32_bf16 v[100:103], a[196:199], a[216:219], v[100:103]
  ds_read_b128 a[160:163], v19 offset:18432
  v_mfma_f32_16x16x32_bf16 v[104:107], a[196:199], a[220:223], v[104:107]
  s_add_u32 s37, s40, 8192
  buffer_load_dwordx4 a[96:99], v3, s[16:19], s37 offen nt
  ds_read_b128 a[164:167], v19 offset:20480
  v_mfma_f32_16x16x32_bf16 v[108:111], a[196:199], a[224:227], v[108:111]
  buffer_load_dwordx4 a[100:103], v4, s[16:19], s37 offen offset:1024 nt
  v_mfma_f32_16x16x32_bf16 v[112:115], a[200:203], a[212:215], v[112:115]
  ds_read_b128 a[168:171], v19 offset:22528
  s_add_u32 s37, s40, 139264
  buffer_load_dwordx4 a[104:107], v3, s[16:19], s37 offen nt
  v_mfma_f32_16x16x32_bf16 v[116:119], a[200:203], a[216:219], v[116:119]
  ds_read_b128 a[172:175], v19 offset:24576
  v_mfma_f32_16x16x32_bf16 v[120:123], a[200:203], a[220:223], v[120:123]
  buffer_load_dwordx4 a[108:111], v4, s[16:19], s37 offen offset:1024 nt
  ds_read_b128 a[176:179], v21 offset:18432
  v_mfma_f32_16x16x32_bf16 v[124:127], a[200:203], a[224:227], v[124:127]
  v_mfma_f32_16x16x32_bf16 v[128:131], a[204:207], a[212:215], v[128:131]
  v_mfma_f32_16x16x32_bf16 v[132:135], a[204:207], a[216:219], v[132:135]
  v_mfma_f32_16x16x32_bf16 v[136:139], a[204:207], a[220:223], v[136:139]
  v_mfma_f32_16x16x32_bf16 v[140:143], a[204:207], a[224:227], v[140:143]
  v_mfma_f32_16x16x32_bf16 v[144:147], a[208:211], a[212:215], v[144:147]
  v_mfma_f32_16x16x32_bf16 v[148:151], a[208:211], a[216:219], v[148:151]
  v_mfma_f32_16x16x32_bf16 v[152:155], a[208:211], a[220:223], v[152:155]
  v_mfma_f32_16x16x32_bf16 v[156:159], a[208:211], a[224:227], v[156:159]
  s_branch concat_heads__gqa_block_cached__mha_block_cached__near_ridge_kernel_qj8
concat_heads__gqa_block_cached__mha_block_cached__near_ridge_kernel_qv6:
  s_waitcnt vmcnt(4) lgkmcnt(0)
  s_barrier
  v_mfma_f32_16x16x32_bf16 v[32:35], a[180:183], a[212:215], v[32:35]
  ds_read_b64_tr_b16 a[128:129], v23 offset:32768
  v_mfma_f32_16x16x32_bf16 v[36:39], a[180:183], a[216:219], v[36:39]
  s_add_u32 m0, s38, 53248
  s_nop 0
  buffer_load_dwordx4 v205, s[8:11], s44 offen  lds
  v_mfma_f32_16x16x32_bf16 v[40:43], a[180:183], a[220:223], v[40:43]
  ds_read_b64_tr_b16 a[130:131], v23 offset:34816
  buffer_load_dwordx4 v206, s[8:11], s44 offen offset:1024  lds
  v_mfma_f32_16x16x32_bf16 v[44:47], a[180:183], a[224:227], v[44:47]
  ds_read_b64_tr_b16 a[132:133], v23 offset:32776
  v_mfma_f32_16x16x32_bf16 v[160:163], a[180:183], a[228:231], v[160:163]
  buffer_load_dwordx4 v207, s[8:11], s44 offen offset:2048  lds
  ds_read_b64_tr_b16 a[134:135], v23 offset:34824
  v_mfma_f32_16x16x32_bf16 v[48:51], a[184:187], a[212:215], v[48:51]
  buffer_load_dwordx4 v208, s[8:11], s44 offen offset:3072  lds
  s_add_u32 s44, s44, 0x40000
  s_and_b32 s44, s44, 0x3fffff
  v_mfma_f32_16x16x32_bf16 v[52:55], a[184:187], a[216:219], v[52:55]
  ds_read_b64_tr_b16 a[136:137], v24 offset:32768
  v_mfma_f32_16x16x32_bf16 v[56:59], a[184:187], a[220:223], v[56:59]
  ds_read_b64_tr_b16 a[138:139], v24 offset:34816
  s_add_u32 m0, s45, 0
  s_nop 0
  buffer_load_dwordx4 v200, s[4:7], s46 offen  lds
  v_mfma_f32_16x16x32_bf16 v[60:63], a[184:187], a[224:227], v[60:63]
  ds_read_b64_tr_b16 a[140:141], v24 offset:32776
  v_mfma_f32_16x16x32_bf16 v[164:167], a[184:187], a[228:231], v[164:167]
  buffer_load_dwordx4 v201, s[4:7], s46 offen offset:1024  lds
  ds_read_b64_tr_b16 a[142:143], v24 offset:34824
  v_mfma_f32_16x16x32_bf16 v[64:67], a[188:191], a[212:215], v[64:67]
  buffer_load_dwordx4 v202, s[4:7], s46 offen offset:2048  lds
  v_mfma_f32_16x16x32_bf16 v[68:71], a[188:191], a[216:219], v[68:71]
  ds_read_b64_tr_b16 a[144:145], v25 offset:32768
  v_mfma_f32_16x16x32_bf16 v[72:75], a[188:191], a[220:223], v[72:75]
  buffer_load_dwordx4 v203, s[4:7], s46 offen offset:3072  lds
  ds_read_b64_tr_b16 a[146:147], v25 offset:34816
  v_mfma_f32_16x16x32_bf16 v[76:79], a[188:191], a[224:227], v[76:79]
  ds_read_b64_tr_b16 a[148:149], v25 offset:32776
  v_mfma_f32_16x16x32_bf16 v[168:171], a[188:191], a[228:231], v[168:171]
  s_cbranch_vccz concat_heads__gqa_block_cached__mha_block_cached__near_ridge_kernel_x510
  s_add_u32 m0, s45, 4096
  s_nop 0
  buffer_load_dwordx4 v204, s[4:7], s46 offen  lds
concat_heads__gqa_block_cached__mha_block_cached__near_ridge_kernel_x510:
  s_add_u32 s46, s46, 128
  s_and_b32 s46, s46, 1023
  ds_read_b64_tr_b16 a[150:151], v25 offset:34824
  v_mfma_f32_16x16x32_bf16 v[80:83], a[192:195], a[212:215], v[80:83]
  s_add_u32 s37, s40, 24576
  buffer_load_dwordx4 a[112:115], v1, s[12:15], s37 offen nt
  v_mfma_f32_16x16x32_bf16 v[84:87], a[192:195], a[216:219], v[84:87]
  ds_read_b64_tr_b16 a[152:153], v26 offset:32768
  v_mfma_f32_16x16x32_bf16 v[88:91], a[192:195], a[220:223], v[88:91]
  buffer_load_dwordx4 a[116:119], v2, s[12:15], s37 offen offset:1024 nt
  ds_read_b64_tr_b16 a[154:155], v26 offset:34816
  v_mfma_f32_16x16x32_bf16 v[92:95], a[192:195], a[224:227], v[92:95]
  s_add_u32 s37, s40, 155648
  buffer_load_dwordx4 a[120:123], v1, s[12:15], s37 offen nt
  v_mfma_f32_16x16x32_bf16 v[172:175], a[192:195], a[228:231], v[172:175]
  ds_read_b64_tr_b16 a[156:157], v26 offset:32776
  buffer_load_dwordx4 a[124:127], v2, s[12:15], s37 offen offset:1024 nt
  v_mfma_f32_16x16x32_bf16 v[96:99], a[196:199], a[212:215], v[96:99]
  s_waitcnt lgkmcnt(7)
  ds_read_b64_tr_b16 a[158:159], v26 offset:34824
  v_mfma_f32_16x16x32_bf16 v[100:103], a[196:199], a[216:219], v[100:103]
  ds_read_b128 a[160:163], v19 offset:18432
  v_mfma_f32_16x16x32_bf16 v[104:107], a[196:199], a[220:223], v[104:107]
  s_add_u32 s37, s40, 16384
  buffer_load_dwordx4 a[232:235], v3, s[16:19], s37 offen nt
  ds_read_b128 a[164:167], v19 offset:20480
  v_mfma_f32_16x16x32_bf16 v[108:111], a[196:199], a[224:227], v[108:111]
  buffer_load_dwordx4 a[236:239], v4, s[16:19], s37 offen offset:1024 nt
  v_mfma_f32_16x16x32_bf16 v[112:115], a[200:203], a[212:215], v[112:115]
  ds_read_b128 a[168:171], v19 offset:22528
  s_add_u32 s37, s40, 147456
  buffer_load_dwordx4 a[240:243], v3, s[16:19], s37 offen nt
  v_mfma_f32_16x16x32_bf16 v[116:119], a[200:203], a[216:219], v[116:119]
  ds_read_b128 a[172:175], v19 offset:24576
  v_mfma_f32_16x16x32_bf16 v[120:123], a[200:203], a[220:223], v[120:123]
  buffer_load_dwordx4 a[244:247], v4, s[16:19], s37 offen offset:1024 nt
  ds_read_b128 a[176:179], v21 offset:18432
  v_mfma_f32_16x16x32_bf16 v[124:127], a[200:203], a[224:227], v[124:127]
  v_mfma_f32_16x16x32_bf16 v[128:131], a[204:207], a[212:215], v[128:131]
  v_mfma_f32_16x16x32_bf16 v[132:135], a[204:207], a[216:219], v[132:135]
  v_mfma_f32_16x16x32_bf16 v[136:139], a[204:207], a[220:223], v[136:139]
  v_mfma_f32_16x16x32_bf16 v[140:143], a[204:207], a[224:227], v[140:143]
  v_mfma_f32_16x16x32_bf16 v[144:147], a[208:211], a[212:215], v[144:147]
  v_mfma_f32_16x16x32_bf16 v[148:151], a[208:211], a[216:219], v[148:151]
  v_mfma_f32_16x16x32_bf16 v[152:155], a[208:211], a[220:223], v[152:155]
  v_mfma_f32_16x16x32_bf16 v[156:159], a[208:211], a[224:227], v[156:159]
  s_branch concat_heads__gqa_block_cached__mha_block_cached__near_ridge_kernel_qj8
concat_heads__gqa_block_cached__mha_block_cached__near_ridge_kernel_qv7:
  s_waitcnt vmcnt(4) lgkmcnt(0)
  s_barrier
  v_mfma_f32_16x16x32_bf16 v[32:35], a[180:183], a[212:215], v[32:35]
  ds_read_b64_tr_b16 a[128:129], v23 offset:32768
  v_mfma_f32_16x16x32_bf16 v[36:39], a[180:183], a[216:219], v[36:39]
  s_add_u32 m0, s38, 53248
  s_nop 0
  buffer_load_dwordx4 v205, s[8:11], s44 offen  lds
  v_mfma_f32_16x16x32_bf16 v[40:43], a[180:183], a[220:223], v[40:43]
  ds_read_b64_tr_b16 a[130:131], v23 offset:34816
  buffer_load_dwordx4 v206, s[8:11], s44 offen offset:1024  lds
  v_mfma_f32_16x16x32_bf16 v[44:47], a[180:183], a[224:227], v[44:47]
  ds_read_b64_tr_b16 a[132:133], v23 offset:32776
  v_mfma_f32_16x16x32_bf16 v[160:163], a[180:183], a[228:231], v[160:163]
  buffer_load_dwordx4 v207, s[8:11], s44 offen offset:2048  lds
  ds_read_b64_tr_b16 a[134:135], v23 offset:34824
  v_mfma_f32_16x16x32_bf16 v[48:51], a[184:187], a[212:215], v[48:51]
  buffer_load_dwordx4 v208, s[8:11], s44 offen offset:3072  lds
  s_add_u32 s44, s44, 0x40000
  s_and_b32 s44, s44, 0x3fffff
  v_mfma_f32_16x16x32_bf16 v[52:55], a[184:187], a[216:219], v[52:55]
  ds_read_b64_tr_b16 a[136:137], v24 offset:32768
  v_mfma_f32_16x16x32_bf16 v[56:59], a[184:187], a[220:223], v[56:59]
  ds_read_b64_tr_b16 a[138:139], v24 offset:34816
  s_add_u32 m0, s45, 0
  s_nop 0
  buffer_load_dwordx4 v200, s[4:7], s46 offen  lds
  v_mfma_f32_16x16x32_bf16 v[60:63], a[184:187], a[224:227], v[60:63]
  ds_read_b64_tr_b16 a[140:141], v24 offset:32776
  v_mfma_f32_16x16x32_bf16 v[164:167], a[184:187], a[228:231], v[164:167]
  buffer_load_dwordx4 v201, s[4:7], s46 offen offset:1024  lds
  ds_read_b64_tr_b16 a[142:143], v24 offset:34824
  v_mfma_f32_16x16x32_bf16 v[64:67], a[188:191], a[212:215], v[64:67]
  buffer_load_dwordx4 v202, s[4:7], s46 offen offset:2048  lds
  v_mfma_f32_16x16x32_bf16 v[68:71], a[188:191], a[216:219], v[68:71]
  ds_read_b64_tr_b16 a[144:145], v25 offset:32768
  v_mfma_f32_16x16x32_bf16 v[72:75], a[188:191], a[220:223], v[72:75]
  buffer_load_dwordx4 v203, s[4:7], s46 offen offset:3072  lds
  ds_read_b64_tr_b16 a[146:147], v25 offset:34816
  v_mfma_f32_16x16x32_bf16 v[76:79], a[188:191], a[224:227], v[76:79]
  ds_read_b64_tr_b16 a[148:149], v25 offset:32776
  v_mfma_f32_16x16x32_bf16 v[168:171], a[188:191], a[228:231], v[168:171]
  s_cbranch_vccz concat_heads__gqa_block_cached__mha_block_cached__near_ridge_kernel_x511
  s_add_u32 m0, s45, 4096
  s_nop 0
  buffer_load_dwordx4 v204, s[4:7], s46 offen  lds
concat_heads__gqa_block_cached__mha_block_cached__near_ridge_kernel_x511:
  s_add_u32 s46, s46, 128
  s_and_b32 s46, s46, 1023
  ds_read_b64_tr_b16 a[150:151], v25 offset:34824
  v_mfma_f32_16x16x32_bf16 v[80:83], a[192:195], a[212:215], v[80:83]
  s_add_u32 s37, s40, 32768
  buffer_load_dwordx4 a[248:251], v1, s[12:15], s37 offen nt
  v_mfma_f32_16x16x32_bf16 v[84:87], a[192:195], a[216:219], v[84:87]
  ds_read_b64_tr_b16 a[152:153], v26 offset:32768
  v_mfma_f32_16x16x32_bf16 v[88:91], a[192:195], a[220:223], v[88:91]
  buffer_load_dwordx4 a[252:255], v2, s[12:15], s37 offen offset:1024 nt
  ds_read_b64_tr_b16 a[154:155], v26 offset:34816
  v_mfma_f32_16x16x32_bf16 v[92:95], a[192:195], a[224:227], v[92:95]
  s_add_u32 s37, s40, 163840
  buffer_load_dwordx4 v[212:215], v1, s[12:15], s37 offen nt
  v_mfma_f32_16x16x32_bf16 v[172:175], a[192:195], a[228:231], v[172:175]
  ds_read_b64_tr_b16 a[156:157], v26 offset:32776
  buffer_load_dwordx4 v[216:219], v2, s[12:15], s37 offen offset:1024 nt
  v_mfma_f32_16x16x32_bf16 v[96:99], a[196:199], a[212:215], v[96:99]
  s_waitcnt lgkmcnt(7)
  ds_read_b64_tr_b16 a[158:159], v26 offset:34824
  v_mfma_f32_16x16x32_bf16 v[100:103], a[196:199], a[216:219], v[100:103]
  ds_read_b128 a[160:163], v19 offset:18432
  v_mfma_f32_16x16x32_bf16 v[104:107], a[196:199], a[220:223], v[104:107]
  s_add_u32 s37, s40, 24576
  buffer_load_dwordx4 v[220:223], v3, s[16:19], s37 offen nt
  ds_read_b128 a[164:167], v19 offset:20480
  v_mfma_f32_16x16x32_bf16 v[108:111], a[196:199], a[224:227], v[108:111]
  buffer_load_dwordx4 v[224:227], v4, s[16:19], s37 offen offset:1024 nt
  v_mfma_f32_16x16x32_bf16 v[112:115], a[200:203], a[212:215], v[112:115]
  ds_read_b128 a[168:171], v19 offset:22528
  s_add_u32 s37, s40, 155648
  buffer_load_dwordx4 v[228:231], v3, s[16:19], s37 offen nt
  v_mfma_f32_16x16x32_bf16 v[116:119], a[200:203], a[216:219], v[116:119]
  ds_read_b128 a[172:175], v19 offset:24576
  v_mfma_f32_16x16x32_bf16 v[120:123], a[200:203], a[220:223], v[120:123]
  buffer_load_dwordx4 v[232:235], v4, s[16:19], s37 offen offset:1024 nt
  ds_read_b128 a[176:179], v21 offset:18432
  v_mfma_f32_16x16x32_bf16 v[124:127], a[200:203], a[224:227], v[124:127]
  v_mfma_f32_16x16x32_bf16 v[128:131], a[204:207], a[212:215], v[128:131]
  v_mfma_f32_16x16x32_bf16 v[132:135], a[204:207], a[216:219], v[132:135]
  v_mfma_f32_16x16x32_bf16 v[136:139], a[204:207], a[220:223], v[136:139]
  v_mfma_f32_16x16x32_bf16 v[140:143], a[204:207], a[224:227], v[140:143]
  v_mfma_f32_16x16x32_bf16 v[144:147], a[208:211], a[212:215], v[144:147]
  v_mfma_f32_16x16x32_bf16 v[148:151], a[208:211], a[216:219], v[148:151]
  v_mfma_f32_16x16x32_bf16 v[152:155], a[208:211], a[220:223], v[152:155]
  v_mfma_f32_16x16x32_bf16 v[156:159], a[208:211], a[224:227], v[156:159]
concat_heads__gqa_block_cached__mha_block_cached__near_ridge_kernel_qj8:
  s_waitcnt vmcnt(20) lgkmcnt(0)
  s_barrier
  v_mfma_f32_16x16x32_bf16 v[32:35], a[128:131], a[160:163], v[32:35]
  v_mfma_f32_16x16x32_bf16 v[36:39], a[128:131], a[164:167], v[36:39]
  ds_read_b64_tr_b16 a[180:181], v23 offset:49152
  v_mfma_f32_16x16x32_bf16 v[40:43], a[128:131], a[168:171], v[40:43]
  ds_read_b64_tr_b16 a[182:183], v23 offset:51200
  v_mfma_f32_16x16x32_bf16 v[44:47], a[128:131], a[172:175], v[44:47]
  ds_read_b64_tr_b16 a[184:185], v23 offset:49160
  v_mfma_f32_16x16x32_bf16 v[160:163], a[128:131], a[176:179], v[160:163]
  s_add_u32 m0, s38, 69632
  s_nop 0
  buffer_load_dwordx4 v205, s[8:11], s44 offen  lds
  v_mfma_f32_16x16x32_bf16 v[48:51], a[132:135], a[160:163], v[48:51]
  ds_read_b64_tr_b16 a[186:187], v23 offset:51208
  v_mfma_f32_16x16x32_bf16 v[52:55], a[132:135], a[164:167], v[52:55]
  ds_read_b64_tr_b16 a[188:189], v24 offset:49152
  v_mfma_f32_16x16x32_bf16 v[56:59], a[132:135], a[168:171], v[56:59]
  ds_read_b64_tr_b16 a[190:191], v24 offset:51200
  v_mfma_f32_16x16x32_bf16 v[60:63], a[132:135], a[172:175], v[60:63]
  ds_read_b64_tr_b16 a[192:193], v24 offset:49160
  v_mfma_f32_16x16x32_bf16 v[164:167], a[132:135], a[176:179], v[164:167]
  ds_read_b64_tr_b16 a[194:195], v24 offset:51208
  v_mfma_f32_16x16x32_bf16 v[64:67], a[136:139], a[160:163], v[64:67]
  buffer_load_dwordx4 v206, s[8:11], s44 offen offset:1024  lds
  v_mfma_f32_16x16x32_bf16 v[68:71], a[136:139], a[164:167], v[68:71]
  ds_read_b64_tr_b16 a[196:197], v25 offset:49152
  v_mfma_f32_16x16x32_bf16 v[72:75], a[136:139], a[168:171], v[72:75]
  ds_read_b64_tr_b16 a[198:199], v25 offset:51200
  v_mfma_f32_16x16x32_bf16 v[76:79], a[136:139], a[172:175], v[76:79]
  v_mfma_f32_16x16x32_bf16 v[168:171], a[136:139], a[176:179], v[168:171]
  ds_read_b64_tr_b16 a[200:201], v25 offset:49160
  v_mfma_f32_16x16x32_bf16 v[80:83], a[140:143], a[160:163], v[80:83]
  ds_read_b64_tr_b16 a[202:203], v25 offset:51208
  v_mfma_f32_16x16x32_bf16 v[84:87], a[140:143], a[164:167], v[84:87]
  ds_read_b64_tr_b16 a[204:205], v26 offset:49152
  v_mfma_f32_16x16x32_bf16 v[88:91], a[140:143], a[168:171], v[88:91]
  buffer_load_dwordx4 v207, s[8:11], s44 offen offset:2048  lds
  v_mfma_f32_16x16x32_bf16 v[92:95], a[140:143], a[172:175], v[92:95]
  ds_read_b64_tr_b16 a[206:207], v26 offset:51200
  v_mfma_f32_16x16x32_bf16 v[172:175], a[140:143], a[176:179], v[172:175]
  ds_read_b64_tr_b16 a[208:209], v26 offset:49160
  v_mfma_f32_16x16x32_bf16 v[96:99], a[144:147], a[160:163], v[96:99]
  s_waitcnt lgkmcnt(7)
  ds_read_b64_tr_b16 a[210:211], v26 offset:51208
  v_mfma_f32_16x16x32_bf16 v[100:103], a[144:147], a[164:167], v[100:103]
  ds_read_b128 a[212:215], v20 offset:18432
  v_mfma_f32_16x16x32_bf16 v[104:107], a[144:147], a[168:171], v[104:107]
  ds_read_b128 a[216:219], v20 offset:20480
  v_mfma_f32_16x16x32_bf16 v[108:111], a[144:147], a[172:175], v[108:111]
  buffer_load_dwordx4 v208, s[8:11], s44 offen offset:3072  lds
  s_add_u32 s44, s44, 0x40000
  s_and_b32 s44, s44, 0x3fffff
  v_mfma_f32_16x16x32_bf16 v[112:115], a[148:151], a[160:163], v[112:115]
  ds_read_b128 a[220:223], v20 offset:22528
  v_mfma_f32_16x16x32_bf16 v[116:119], a[148:151], a[164:167], v[116:119]
  ds_read_b128 a[224:227], v20 offset:24576
  v_mfma_f32_16x16x32_bf16 v[120:123], a[148:151], a[168:171], v[120:123]
  ds_read_b128 a[228:231], v22 offset:18432
  v_mfma_f32_16x16x32_bf16 v[124:127], a[148:151], a[172:175], v[124:127]
  v_mfma_f32_16x16x32_bf16 v[128:131], a[152:155], a[160:163], v[128:131]
  v_mfma_f32_16x16x32_bf16 v[132:135], a[152:155], a[164:167], v[132:135]
  v_mfma_f32_16x16x32_bf16 v[136:139], a[152:155], a[168:171], v[136:139]
  v_mfma_f32_16x16x32_bf16 v[140:143], a[152:155], a[172:175], v[140:143]
  v_mfma_f32_16x16x32_bf16 v[144:147], a[156:159], a[160:163], v[144:147]
  v_mfma_f32_16x16x32_bf16 v[148:151], a[156:159], a[164:167], v[148:151]
  v_mfma_f32_16x16x32_bf16 v[152:155], a[156:159], a[168:171], v[152:155]
  v_mfma_f32_16x16x32_bf16 v[156:159], a[156:159], a[172:175], v[156:159]
  s_waitcnt vmcnt(12) lgkmcnt(0)
  s_barrier
  v_mfma_f32_16x16x32_bf16 v[32:35], a[180:183], a[212:215], v[32:35]
  ds_read_b64_tr_b16 a[128:129], v23 offset:0
  v_mfma_f32_16x16x32_bf16 v[36:39], a[180:183], a[216:219], v[36:39]
  s_add_u32 m0, s38, 86016
  s_nop 0
  buffer_load_dwordx4 v205, s[8:11], s44 offen  lds
  v_mfma_f32_16x16x32_bf16 v[40:43], a[180:183], a[220:223], v[40:43]
  ds_read_b64_tr_b16 a[130:131], v23 offset:2048
  v_mfma_f32_16x16x32_bf16 v[44:47], a[180:183], a[224:227], v[44:47]
  ds_read_b64_tr_b16 a[132:133], v23 offset:8
  v_mfma_f32_16x16x32_bf16 v[160:163], a[180:183], a[228:231], v[160:163]
  ds_read_b64_tr_b16 a[134:135], v23 offset:2056
  v_mfma_f32_16x16x32_bf16 v[48:51], a[184:187], a[212:215], v[48:51]
  buffer_load_dwordx4 v206, s[8:11], s44 offen offset:1024  lds
  v_mfma_f32_16x16x32_bf16 v[52:55], a[184:187], a[216:219], v[52:55]
  ds_read_b64_tr_b16 a[136:137], v24 offset:0
  v_mfma_f32_16x16x32_bf16 v[56:59], a[184:187], a[220:223], v[56:59]
  ds_read_b64_tr_b16 a[138:139], v24 offset:2048
  v_mfma_f32_16x16x32_bf16 v[60:63], a[184:187], a[224:227], v[60:63]
  buffer_load_dwordx4 v207, s[8:11], s44 offen offset:2048  lds
  ds_read_b64_tr_b16 a[140:141], v24 offset:8
  v_mfma_f32_16x16x32_bf16 v[164:167], a[184:187], a[228:231], v[164:167]
  ds_read_b64_tr_b16 a[142:143], v24 offset:2056
  v_mfma_f32_16x16x32_bf16 v[64:67], a[188:191], a[212:215], v[64:67]
  buffer_load_dwordx4 v208, s[8:11], s44 offen offset:3072  lds
  s_add_u32 s44, s44, 0x40000
  s_and_b32 s44, s44, 0x3fffff
  v_mfma_f32_16x16x32_bf16 v[68:71], a[188:191], a[216:219], v[68:71]
  ds_read_b64_tr_b16 a[144:145], v25 offset:0
  v_mfma_f32_16x16x32_bf16 v[72:75], a[188:191], a[220:223], v[72:75]
  ds_read_b64_tr_b16 a[146:147], v25 offset:2048
  v_mfma_f32_16x16x32_bf16 v[76:79], a[188:191], a[224:227], v[76:79]
  ds_read_b64_tr_b16 a[148:149], v25 offset:8
  v_mfma_f32_16x16x32_bf16 v[168:171], a[188:191], a[228:231], v[168:171]
  s_add_u32 m0, s45, 18432
  s_nop 0
  buffer_load_dwordx4 v200, s[4:7], s46 offen  lds
  v_mfma_f32_16x16x32_bf16 v[80:83], a[192:195], a[212:215], v[80:83]
  ds_read_b64_tr_b16 a[150:151], v25 offset:2056
  v_mfma_f32_16x16x32_bf16 v[84:87], a[192:195], a[216:219], v[84:87]
  ds_read_b64_tr_b16 a[152:153], v26 offset:0
  v_mfma_f32_16x16x32_bf16 v[88:91], a[192:195], a[220:223], v[88:91]
  buffer_load_dwordx4 v201, s[4:7], s46 offen offset:1024  lds
  ds_read_b64_tr_b16 a[154:155], v26 offset:2048
  v_mfma_f32_16x16x32_bf16 v[92:95], a[192:195], a[224:227], v[92:95]
  ds_read_b64_tr_b16 a[156:157], v26 offset:8
  v_mfma_f32_16x16x32_bf16 v[172:175], a[192:195], a[228:231], v[172:175]
  buffer_load_dwordx4 v202, s[4:7], s46 offen offset:2048  lds
  v_mfma_f32_16x16x32_bf16 v[96:99], a[196:199], a[212:215], v[96:99]
  s_waitcnt lgkmcnt(7)
  ds_read_b64_tr_b16 a[158:159], v26 offset:2056
  v_mfma_f32_16x16x32_bf16 v[100:103], a[196:199], a[216:219], v[100:103]
  ds_read_b128 a[160:163], v19 offset:0
  v_mfma_f32_16x16x32_bf16 v[104:107], a[196:199], a[220:223], v[104:107]
  ds_read_b128 a[164:167], v19 offset:2048
  v_mfma_f32_16x16x32_bf16 v[108:111], a[196:199], a[224:227], v[108:111]
  buffer_load_dwordx4 v203, s[4:7], s46 offen offset:3072  lds
  v_mfma_f32_16x16x32_bf16 v[112:115], a[200:203], a[212:215], v[112:115]
  ds_read_b128 a[168:171], v19 offset:4096
  v_mfma_f32_16x16x32_bf16 v[116:119], a[200:203], a[216:219], v[116:119]
  ds_read_b128 a[172:175], v19 offset:6144
  v_mfma_f32_16x16x32_bf16 v[120:123], a[200:203], a[220:223], v[120:123]
  s_cbranch_vccz concat_heads__gqa_block_cached__mha_block_cached__near_ridge_kernel_x512
  s_add_u32 m0, s45, 22528
  s_nop 0
  buffer_load_dwordx4 v204, s[4:7], s46 offen  lds
concat_heads__gqa_block_cached__mha_block_cached__near_ridge_kernel_x512:
  s_add_u32 s46, s46, 128
  s_and_b32 s46, s46, 1023
  ds_read_b128 a[176:179], v21 offset:0
  v_mfma_f32_16x16x32_bf16 v[124:127], a[200:203], a[224:227], v[124:127]
  v_mfma_f32_16x16x32_bf16 v[128:131], a[204:207], a[212:215], v[128:131]
  v_mfma_f32_16x16x32_bf16 v[132:135], a[204:207], a[216:219], v[132:135]
  v_mfma_f32_16x16x32_bf16 v[136:139], a[204:207], a[220:223], v[136:139]
  v_mfma_f32_16x16x32_bf16 v[140:143], a[204:207], a[224:227], v[140:143]
  v_mfma_f32_16x16x32_bf16 v[144:147], a[208:211], a[212:215], v[144:147]
  v_mfma_f32_16x16x32_bf16 v[148:151], a[208:211], a[216:219], v[148:151]
  v_mfma_f32_16x16x32_bf16 v[152:155], a[208:211], a[220:223], v[152:155]
  v_mfma_f32_16x16x32_bf16 v[156:159], a[208:211], a[224:227], v[156:159]
  s_add_u32 s30, s30, 1
  s_cmp_lt_u32 s30, 3
  s_cbranch_scc1 concat_heads__gqa_block_cached__mha_block_cached__near_ridge_kernel_qloop
  s_waitcnt vmcnt(24) lgkmcnt(0)
  s_barrier
  v_mfma_f32_16x16x32_bf16 v[32:35], a[128:131], a[160:163], v[32:35]
  v_mfma_f32_16x16x32_bf16 v[36:39], a[128:131], a[164:167], v[36:39]
  ds_read_b64_tr_b16 a[180:181], v23 offset:16384
  v_mfma_f32_16x16x32_bf16 v[40:43], a[128:131], a[168:171], v[40:43]
  ds_read_b64_tr_b16 a[182:183], v23 offset:18432
  v_mfma_f32_16x16x32_bf16 v[44:47], a[128:131], a[172:175], v[44:47]
  ds_read_b64_tr_b16 a[184:185], v23 offset:16392
  v_mfma_f32_16x16x32_bf16 v[160:163], a[128:131], a[176:179], v[160:163]
  ds_read_b64_tr_b16 a[186:187], v23 offset:18440
  v_mfma_f32_16x16x32_bf16 v[48:51], a[132:135], a[160:163], v[48:51]
  ds_read_b64_tr_b16 a[188:189], v24 offset:16384
  v_mfma_f32_16x16x32_bf16 v[52:55], a[132:135], a[164:167], v[52:55]
  v_mfma_f32_16x16x32_bf16 v[56:59], a[132:135], a[168:171], v[56:59]
  s_add_u32 m0, s39, 114688
  s_add_u32 s37, s40, 0
  buffer_load_dwordx4 v1, s[12:15], s37 offen nt lds
  buffer_load_dwordx4 v2, s[12:15], s37 offen offset:1024 nt lds
  v_mfma_f32_16x16x32_bf16 v[60:63], a[132:135], a[172:175], v[60:63]
  ds_read_b64_tr_b16 a[190:191], v24 offset:18432
  v_mfma_f32_16x16x32_bf16 v[164:167], a[132:135], a[176:179], v[164:167]
  ds_read_b64_tr_b16 a[192:193], v24 offset:16392
  v_mfma_f32_16x16x32_bf16 v[64:67], a[136:139], a[160:163], v[64:67]
  ds_read_b64_tr_b16 a[194:195], v24 offset:18440
  v_mfma_f32_16x16x32_bf16 v[68:71], a[136:139], a[164:167], v[68:71]
  ds_read_b64_tr_b16 a[196:197], v25 offset:16384
  v_mfma_f32_16x16x32_bf16 v[72:75], a[136:139], a[168:171], v[72:75]
  ds_read_b64_tr_b16 a[198:199], v25 offset:18432
  v_mfma_f32_16x16x32_bf16 v[76:79], a[136:139], a[172:175], v[76:79]
  v_mfma_f32_16x16x32_bf16 v[168:171], a[136:139], a[176:179], v[168:171]
  ds_read_b64_tr_b16 a[200:201], v25 offset:16392
  v_mfma_f32_16x16x32_bf16 v[80:83], a[140:143], a[160:163], v[80:83]
  ds_read_b64_tr_b16 a[202:203], v25 offset:18440
  v_mfma_f32_16x16x32_bf16 v[84:87], a[140:143], a[164:167], v[84:87]
  ds_read_b64_tr_b16 a[204:205], v26 offset:16384
  v_mfma_f32_16x16x32_bf16 v[88:91], a[140:143], a[168:171], v[88:91]
  ds_read_b64_tr_b16 a[206:207], v26 offset:18432
  v_mfma_f32_16x16x32_bf16 v[92:95], a[140:143], a[172:175], v[92:95]
  ds_read_b64_tr_b16 a[208:209], v26 offset:16392
  v_mfma_f32_16x16x32_bf16 v[172:175], a[140:143], a[176:179], v[172:175]
  s_waitcnt lgkmcnt(7)
  ds_read_b64_tr_b16 a[210:211], v26 offset:18440
  v_mfma_f32_16x16x32_bf16 v[96:99], a[144:147], a[160:163], v[96:99]
  v_mfma_f32_16x16x32_bf16 v[100:103], a[144:147], a[164:167], v[100:103]
  s_add_u32 m0, s39, 122880
  s_add_u32 s37, s40, 131072
  buffer_load_dwordx4 v1, s[12:15], s37 offen nt lds
  buffer_load_dwordx4 v2, s[12:15], s37 offen offset:1024 nt lds
  v_mfma_f32_16x16x32_bf16 v[104:107], a[144:147], a[168:171], v[104:107]
  ds_read_b128 a[212:215], v20 offset:0
  v_mfma_f32_16x16x32_bf16 v[108:111], a[144:147], a[172:175], v[108:111]
  ds_read_b128 a[216:219], v20 offset:2048
  v_mfma_f32_16x16x32_bf16 v[112:115], a[148:151], a[160:163], v[112:115]
  ds_read_b128 a[220:223], v20 offset:4096
  v_mfma_f32_16x16x32_bf16 v[116:119], a[148:151], a[164:167], v[116:119]
  ds_read_b128 a[224:227], v20 offset:6144
  v_mfma_f32_16x16x32_bf16 v[120:123], a[148:151], a[168:171], v[120:123]
  ds_read_b128 a[228:231], v22 offset:0
  v_mfma_f32_16x16x32_bf16 v[124:127], a[148:151], a[172:175], v[124:127]
  v_mfma_f32_16x16x32_bf16 v[128:131], a[152:155], a[160:163], v[128:131]
  v_mfma_f32_16x16x32_bf16 v[132:135], a[152:155], a[164:167], v[132:135]
  v_mfma_f32_16x16x32_bf16 v[136:139], a[152:155], a[168:171], v[136:139]
  v_mfma_f32_16x16x32_bf16 v[140:143], a[152:155], a[172:175], v[140:143]
  v_mfma_f32_16x16x32_bf16 v[144:147], a[156:159], a[160:163], v[144:147]
  v_mfma_f32_16x16x32_bf16 v[148:151], a[156:159], a[164:167], v[148:151]
  v_mfma_f32_16x16x32_bf16 v[152:155], a[156:159], a[168:171], v[152:155]
  v_mfma_f32_16x16x32_bf16 v[156:159], a[156:159], a[172:175], v[156:159]
  s_waitcnt vmcnt(4) lgkmcnt(0)
  s_barrier
  v_mfma_f32_16x16x32_bf16 v[32:35], a[180:183], a[212:215], v[32:35]
  v_mfma_f32_16x16x32_bf16 v[36:39], a[180:183], a[216:219], v[36:39]
  ds_read_b64_tr_b16 a[128:129], v23 offset:32768
  v_mfma_f32_16x16x32_bf16 v[40:43], a[180:183], a[220:223], v[40:43]
  ds_read_b64_tr_b16 a[130:131], v23 offset:34816
  v_mfma_f32_16x16x32_bf16 v[44:47], a[180:183], a[224:227], v[44:47]
  ds_read_b64_tr_b16 a[132:133], v23 offset:32776
  v_mfma_f32_16x16x32_bf16 v[160:163], a[180:183], a[228:231], v[160:163]
  s_add_u32 m0, s39, 131072
  s_add_u32 s37, s40, 8192
  buffer_load_dwordx4 v1, s[12:15], s37 offen nt lds
  buffer_load_dwordx4 v2, s[12:15], s37 offen offset:1024 nt lds
  v_mfma_f32_16x16x32_bf16 v[48:51], a[184:187], a[212:215], v[48:51]
  ds_read_b64_tr_b16 a[134:135], v23 offset:34824
  v_mfma_f32_16x16x32_bf16 v[52:55], a[184:187], a[216:219], v[52:55]
  ds_read_b64_tr_b16 a[136:137], v24 offset:32768
  v_mfma_f32_16x16x32_bf16 v[56:59], a[184:187], a[220:223], v[56:59]
  ds_read_b64_tr_b16 a[138:139], v24 offset:34816
  v_mfma_f32_16x16x32_bf16 v[60:63], a[184:187], a[224:227], v[60:63]
  ds_read_b64_tr_b16 a[140:141], v24 offset:32776
  v_mfma_f32_16x16x32_bf16 v[164:167], a[184:187], a[228:231], v[164:167]
  ds_read_b64_tr_b16 a[142:143], v24 offset:34824
  v_mfma_f32_16x16x32_bf16 v[64:67], a[188:191], a[212:215], v[64:67]
  s_add_u32 m0, s39, 139264
  s_add_u32 s37, s40, 139264
  buffer_load_dwordx4 v1, s[12:15], s37 offen nt lds
  buffer_load_dwordx4 v2, s[12:15], s37 offen offset:1024 nt lds
  v_mfma_f32_16x16x32_bf16 v[68:71], a[188:191], a[216:219], v[68:71]
  ds_read_b64_tr_b16 a[144:145], v25 offset:32768
  v_mfma_f32_16x16x32_bf16 v[72:75], a[188:191], a[220:223], v[72:75]
  ds_read_b64_tr_b16 a[146:147], v25 offset:34816
  v_mfma_f32_16x16x32_bf16 v[76:79], a[188:191], a[224:227], v[76:79]
  v_mfma_f32_16x16x32_bf16 v[168:171], a[188:191], a[228:231], v[168:171]
  ds_read_b64_tr_b16 a[148:149], v25 offset:32776
  v_mfma_f32_16x16x32_bf16 v[80:83], a[192:195], a[212:215], v[80:83]
  ds_read_b64_tr_b16 a[150:151], v25 offset:34824
  v_mfma_f32_16x16x32_bf16 v[84:87], a[192:195], a[216:219], v[84:87]
  ds_read_b64_tr_b16 a[152:153], v26 offset:32768
  v_mfma_f32_16x16x32_bf16 v[88:91], a[192:195], a[220:223], v[88:91]
  s_add_u32 m0, s39, 147456
  s_add_u32 s37, s40, 0
  buffer_load_dwordx4 v3, s[16:19], s37 offen nt lds
  buffer_load_dwordx4 v4, s[16:19], s37 offen offset:1024 nt lds
  v_mfma_f32_16x16x32_bf16 v[92:95], a[192:195], a[224:227], v[92:95]
  ds_read_b64_tr_b16 a[154:155], v26 offset:34816
  v_mfma_f32_16x16x32_bf16 v[172:175], a[192:195], a[228:231], v[172:175]
  ds_read_b64_tr_b16 a[156:157], v26 offset:32776
  v_mfma_f32_16x16x32_bf16 v[96:99], a[196:199], a[212:215], v[96:99]
  s_waitcnt lgkmcnt(7)
  ds_read_b64_tr_b16 a[158:159], v26 offset:34824
  v_mfma_f32_16x16x32_bf16 v[100:103], a[196:199], a[216:219], v[100:103]
  ds_read_b128 a[160:163], v19 offset:18432
  v_mfma_f32_16x16x32_bf16 v[104:107], a[196:199], a[220:223], v[104:107]
  ds_read_b128 a[164:167], v19 offset:20480
  v_mfma_f32_16x16x32_bf16 v[108:111], a[196:199], a[224:227], v[108:111]
  s_add_u32 m0, s39, 155648
  s_add_u32 s37, s40, 131072
  buffer_load_dwordx4 v3, s[16:19], s37 offen nt lds
  buffer_load_dwordx4 v4, s[16:19], s37 offen offset:1024 nt lds
  v_mfma_f32_16x16x32_bf16 v[112:115], a[200:203], a[212:215], v[112:115]
  ds_read_b128 a[168:171], v19 offset:22528
  v_mfma_f32_16x16x32_bf16 v[116:119], a[200:203], a[216:219], v[116:119]
  ds_read_b128 a[172:175], v19 offset:24576
  v_mfma_f32_16x16x32_bf16 v[120:123], a[200:203], a[220:223], v[120:123]
  ds_read_b128 a[176:179], v21 offset:18432
  v_mfma_f32_16x16x32_bf16 v[124:127], a[200:203], a[224:227], v[124:127]
  v_mfma_f32_16x16x32_bf16 v[128:131], a[204:207], a[212:215], v[128:131]
  v_mfma_f32_16x16x32_bf16 v[132:135], a[204:207], a[216:219], v[132:135]
  v_mfma_f32_16x16x32_bf16 v[136:139], a[204:207], a[220:223], v[136:139]
  v_mfma_f32_16x16x32_bf16 v[140:143], a[204:207], a[224:227], v[140:143]
  v_mfma_f32_16x16x32_bf16 v[144:147], a[208:211], a[212:215], v[144:147]
  v_mfma_f32_16x16x32_bf16 v[148:151], a[208:211], a[216:219], v[148:151]
  v_mfma_f32_16x16x32_bf16 v[152:155], a[208:211], a[220:223], v[152:155]
  v_mfma_f32_16x16x32_bf16 v[156:159], a[208:211], a[224:227], v[156:159]
  s_waitcnt vmcnt(16) lgkmcnt(0)
  s_barrier
  v_mfma_f32_16x16x32_bf16 v[32:35], a[128:131], a[160:163], v[32:35]
  v_mfma_f32_16x16x32_bf16 v[36:39], a[128:131], a[164:167], v[36:39]
  ds_read_b64_tr_b16 a[180:181], v23 offset:49152
  v_mfma_f32_16x16x32_bf16 v[40:43], a[128:131], a[168:171], v[40:43]
  ds_read_b64_tr_b16 a[182:183], v23 offset:51200
  v_mfma_f32_16x16x32_bf16 v[44:47], a[128:131], a[172:175], v[44:47]
  ds_read_b64_tr_b16 a[184:185], v23 offset:49160
  v_mfma_f32_16x16x32_bf16 v[160:163], a[128:131], a[176:179], v[160:163]
  v_mfma_f32_16x16x32_bf16 v[48:51], a[132:135], a[160:163], v[48:51]
  ds_read_b64_tr_b16 a[186:187], v23 offset:51208
  v_mfma_f32_16x16x32_bf16 v[52:55], a[132:135], a[164:167], v[52:55]
  ds_read_b64_tr_b16 a[188:189], v24 offset:49152
  v_mfma_f32_16x16x32_bf16 v[56:59], a[132:135], a[168:171], v[56:59]
  ds_read_b64_tr_b16 a[190:191], v24 offset:51200
  v_mfma_f32_16x16x32_bf16 v[60:63], a[132:135], a[172:175], v[60:63]
  ds_read_b64_tr_b16 a[192:193], v24 offset:49160
  v_mfma_f32_16x16x32_bf16 v[164:167], a[132:135], a[176:179], v[164:167]
  v_mfma_f32_16x16x32_bf16 v[64:67], a[136:139], a[160:163], v[64:67]
  ds_read_b64_tr_b16 a[194:195], v24 offset:51208
  v_mfma_f32_16x16x32_bf16 v[68:71], a[136:139], a[164:167], v[68:71]
  ds_read_b64_tr_b16 a[196:197], v25 offset:49152
  v_mfma_f32_16x16x32_bf16 v[72:75], a[136:139], a[168:171], v[72:75]
  ds_read_b64_tr_b16 a[198:199], v25 offset:51200
  v_mfma_f32_16x16x32_bf16 v[76:79], a[136:139], a[172:175], v[76:79]
  v_mfma_f32_16x16x32_bf16 v[168:171], a[136:139], a[176:179], v[168:171]
  ds_read_b64_tr_b16 a[200:201], v25 offset:49160
  v_mfma_f32_16x16x32_bf16 v[80:83], a[140:143], a[160:163], v[80:83]
  ds_read_b64_tr_b16 a[202:203], v25 offset:51208
  v_mfma_f32_16x16x32_bf16 v[84:87], a[140:143], a[164:167], v[84:87]
  ds_read_b64_tr_b16 a[204:205], v26 offset:49152
  v_mfma_f32_16x16x32_bf16 v[88:91], a[140:143], a[168:171], v[88:91]
  ds_read_b64_tr_b16 a[206:207], v26 offset:51200
  v_mfma_f32_16x16x32_bf16 v[92:95], a[140:143], a[172:175], v[92:95]
  v_mfma_f32_16x16x32_bf16 v[172:175], a[140:143], a[176:179], v[172:175]
  ds_read_b64_tr_b16 a[208:209], v26 offset:49160
  v_mfma_f32_16x16x32_bf16 v[96:99], a[144:147], a[160:163], v[96:99]
  s_waitcnt lgkmcnt(7)
  ds_read_b64_tr_b16 a[210:211], v26 offset:51208
  v_mfma_f32_16x16x32_bf16 v[100:103], a[144:147], a[164:167], v[100:103]
  ds_read_b128 a[212:215], v20 offset:18432
  v_mfma_f32_16x16x32_bf16 v[104:107], a[144:147], a[168:171], v[104:107]
  v_mfma_f32_16x16x32_bf16 v[108:111], a[144:147], a[172:175], v[108:111]
  ds_read_b128 a[216:219], v20 offset:20480
  v_mfma_f32_16x16x32_bf16 v[112:115], a[148:151], a[160:163], v[112:115]
  ds_read_b128 a[220:223], v20 offset:22528
  v_mfma_f32_16x16x32_bf16 v[116:119], a[148:151], a[164:167], v[116:119]
  ds_read_b128 a[224:227], v20 offset:24576
  v_mfma_f32_16x16x32_bf16 v[120:123], a[148:151], a[168:171], v[120:123]
  ds_read_b128 a[228:231], v22 offset:18432
  v_mfma_f32_16x16x32_bf16 v[124:127], a[148:151], a[172:175], v[124:127]
  v_mfma_f32_16x16x32_bf16 v[128:131], a[152:155], a[160:163], v[128:131]
  v_mfma_f32_16x16x32_bf16 v[132:135], a[152:155], a[164:167], v[132:135]
  v_mfma_f32_16x16x32_bf16 v[136:139], a[152:155], a[168:171], v[136:139]
  v_mfma_f32_16x16x32_bf16 v[140:143], a[152:155], a[172:175], v[140:143]
  v_mfma_f32_16x16x32_bf16 v[144:147], a[156:159], a[160:163], v[144:147]
  v_mfma_f32_16x16x32_bf16 v[148:151], a[156:159], a[164:167], v[148:151]
  v_mfma_f32_16x16x32_bf16 v[152:155], a[156:159], a[168:171], v[152:155]
  v_mfma_f32_16x16x32_bf16 v[156:159], a[156:159], a[172:175], v[156:159]
  v_lshlrev_b32 v28, 4, v0
  v_add_u32 v28, s39, v28
  v_add_u32 v29, 0x10000, v28
  s_waitcnt lgkmcnt(0)
  s_barrier
  v_mfma_f32_16x16x32_bf16 v[32:35], a[180:183], a[212:215], v[32:35]
  v_mfma_f32_16x16x32_bf16 v[36:39], a[180:183], a[216:219], v[36:39]
  ds_write_b128 v28, a[80:83] offset:0
  v_mfma_f32_16x16x32_bf16 v[40:43], a[180:183], a[220:223], v[40:43]
  ds_write_b128 v28, a[84:87] offset:1024
  v_mfma_f32_16x16x32_bf16 v[44:47], a[180:183], a[224:227], v[44:47]
  ds_write_b128 v28, a[88:91] offset:8192
  v_mfma_f32_16x16x32_bf16 v[160:163], a[180:183], a[228:231], v[160:163]
  ds_write_b128 v28, a[92:95] offset:9216
  v_mfma_f32_16x16x32_bf16 v[48:51], a[184:187], a[212:215], v[48:51]
  ds_write_b128 v28, a[96:99] offset:16384
  v_mfma_f32_16x16x32_bf16 v[52:55], a[184:187], a[216:219], v[52:55]
  ds_write_b128 v28, a[100:103] offset:17408
  v_mfma_f32_16x16x32_bf16 v[56:59], a[184:187], a[220:223], v[56:59]
  ds_write_b128 v28, a[104:107] offset:24576
  v_mfma_f32_16x16x32_bf16 v[60:63], a[184:187], a[224:227], v[60:63]
  ds_write_b128 v28, a[108:111] offset:25600
  v_mfma_f32_16x16x32_bf16 v[164:167], a[184:187], a[228:231], v[164:167]
  v_mfma_f32_16x16x32_bf16 v[64:67], a[188:191], a[212:215], v[64:67]
  ds_write_b128 v28, a[112:115] offset:32768
  v_mfma_f32_16x16x32_bf16 v[68:71], a[188:191], a[216:219], v[68:71]
  ds_write_b128 v28, a[116:119] offset:33792
  v_mfma_f32_16x16x32_bf16 v[72:75], a[188:191], a[220:223], v[72:75]
  ds_write_b128 v28, a[120:123] offset:40960
  v_mfma_f32_16x16x32_bf16 v[76:79], a[188:191], a[224:227], v[76:79]
  ds_write_b128 v28, a[124:127] offset:41984
  v_mfma_f32_16x16x32_bf16 v[168:171], a[188:191], a[228:231], v[168:171]
  ds_write_b128 v28, a[232:235] offset:49152
  v_mfma_f32_16x16x32_bf16 v[80:83], a[192:195], a[212:215], v[80:83]
  ds_write_b128 v28, a[236:239] offset:50176
  v_mfma_f32_16x16x32_bf16 v[84:87], a[192:195], a[216:219], v[84:87]
  ds_write_b128 v28, a[240:243] offset:57344
  v_mfma_f32_16x16x32_bf16 v[88:91], a[192:195], a[220:223], v[88:91]
  s_waitcnt lgkmcnt(7)
  ds_write_b128 v28, a[244:247] offset:58368
  v_mfma_f32_16x16x32_bf16 v[92:95], a[192:195], a[224:227], v[92:95]
  v_mfma_f32_16x16x32_bf16 v[172:175], a[192:195], a[228:231], v[172:175]
  ds_write_b128 v29, a[248:251] offset:0
  v_mfma_f32_16x16x32_bf16 v[96:99], a[196:199], a[212:215], v[96:99]
  ds_write_b128 v29, a[252:255] offset:1024
  v_mfma_f32_16x16x32_bf16 v[100:103], a[196:199], a[216:219], v[100:103]
  ds_write_b128 v29, v[212:215] offset:8192
  v_mfma_f32_16x16x32_bf16 v[104:107], a[196:199], a[220:223], v[104:107]
  ds_write_b128 v29, v[216:219] offset:9216
  v_mfma_f32_16x16x32_bf16 v[108:111], a[196:199], a[224:227], v[108:111]
  ds_write_b128 v29, v[220:223] offset:16384
  v_mfma_f32_16x16x32_bf16 v[112:115], a[200:203], a[212:215], v[112:115]
  ds_write_b128 v29, v[224:227] offset:17408
  v_mfma_f32_16x16x32_bf16 v[116:119], a[200:203], a[216:219], v[116:119]
  ds_write_b128 v29, v[228:231] offset:24576
  v_mfma_f32_16x16x32_bf16 v[120:123], a[200:203], a[220:223], v[120:123]
  s_waitcnt lgkmcnt(7)
  ds_write_b128 v29, v[232:235] offset:25600
  v_mfma_f32_16x16x32_bf16 v[124:127], a[200:203], a[224:227], v[124:127]
  v_mfma_f32_16x16x32_bf16 v[128:131], a[204:207], a[212:215], v[128:131]
  v_mfma_f32_16x16x32_bf16 v[132:135], a[204:207], a[216:219], v[132:135]
  v_mfma_f32_16x16x32_bf16 v[136:139], a[204:207], a[220:223], v[136:139]
  v_mfma_f32_16x16x32_bf16 v[140:143], a[204:207], a[224:227], v[140:143]
  v_mfma_f32_16x16x32_bf16 v[144:147], a[208:211], a[212:215], v[144:147]
  v_mfma_f32_16x16x32_bf16 v[148:151], a[208:211], a[216:219], v[148:151]
  v_mfma_f32_16x16x32_bf16 v[152:155], a[208:211], a[220:223], v[152:155]
  v_mfma_f32_16x16x32_bf16 v[156:159], a[208:211], a[224:227], v[156:159]
  s_waitcnt lgkmcnt(0)
  s_mov_b32 s48, 0x3e0293ee
  s_mov_b32 s49, 0x3e0293ee
  v_pk_mul_f32 v[160:161], v[160:161], s[48:49]
  v_pk_mul_f32 v[162:163], v[162:163], s[48:49]
  v_cvt_pk_bf16_f32 v176, v160, v161
  v_cvt_pk_bf16_f32 v177, v162, v163
  v_pk_mul_f32 v[164:165], v[164:165], s[48:49]
  v_pk_mul_f32 v[166:167], v[166:167], s[48:49]
  v_cvt_pk_bf16_f32 v178, v164, v165
  v_cvt_pk_bf16_f32 v179, v166, v167
  v_accvgpr_write_b32 a64, v176
  v_accvgpr_write_b32 a65, v177
  v_accvgpr_write_b32 a66, v178
  v_accvgpr_write_b32 a67, v179
  s_add_u32 s52, s39, 106496
  v_lshlrev_b32 v27, 4, v0
  v_add_u32 v27, s52, v27
  ds_write_b128 v27, v[176:179] offset:0
  v_pk_mul_f32 v[168:169], v[168:169], s[48:49]
  v_pk_mul_f32 v[170:171], v[170:171], s[48:49]
  v_cvt_pk_bf16_f32 v180, v168, v169
  v_cvt_pk_bf16_f32 v181, v170, v171
  v_pk_mul_f32 v[172:173], v[172:173], s[48:49]
  v_pk_mul_f32 v[174:175], v[174:175], s[48:49]
  v_cvt_pk_bf16_f32 v182, v172, v173
  v_cvt_pk_bf16_f32 v183, v174, v175
  v_accvgpr_write_b32 a68, v180
  v_accvgpr_write_b32 a69, v181
  v_accvgpr_write_b32 a70, v182
  v_accvgpr_write_b32 a71, v183
  ds_write_b128 v27, v[180:183] offset:1024
  s_waitcnt vmcnt(8) lgkmcnt(0)
  s_barrier
  v_xor_b32 v27, 0x800, v27
  ds_read_b128 a[72:75], v27
  ds_read_b128 a[76:79], v27 offset:1024
  s_cmp_eq_u32 s24, 0
  s_cbranch_scc0 concat_heads__gqa_block_cached__mha_block_cached__near_ridge_kernel_k0p13
  ds_read_b128 a[100:103], v5 offset:16384
  ds_read_b128 a[104:107], v6 offset:16384
  ds_read_b128 a[108:111], v7 offset:16384
  ds_read_b128 a[112:115], v8 offset:16384
  ds_read_b128 a[116:119], v5 offset:20480
  ds_read_b128 a[120:123], v6 offset:20480
  ds_read_b128 a[124:127], v7 offset:20480
  ds_read_b128 a[128:131], v8 offset:20480
  s_branch concat_heads__gqa_block_cached__mha_block_cached__near_ridge_kernel_k0d14
concat_heads__gqa_block_cached__mha_block_cached__near_ridge_kernel_k0p13:
  ds_read_b128 a[132:135], v5 offset:16384
  ds_read_b128 a[136:139], v6 offset:16384
  ds_read_b128 a[140:143], v7 offset:16384
  ds_read_b128 a[144:147], v8 offset:16384
  ds_read_b128 a[148:151], v5 offset:20480
  s_waitcnt lgkmcnt(7)
  ds_read_b128 a[152:155], v6 offset:20480
  ds_read_b128 a[156:159], v7 offset:20480
  ds_read_b128 a[160:163], v8 offset:20480
concat_heads__gqa_block_cached__mha_block_cached__near_ridge_kernel_k0d14:
  s_waitcnt lgkmcnt(0)
  s_barrier
  s_add_u32 m0, s39, 98304
  s_add_u32 s37, s40, 40960
  buffer_load_dwordx4 v1, s[12:15], s37 offen nt lds
  buffer_load_dwordx4 v2, s[12:15], s37 offen offset:1024 nt lds
  s_add_u32 m0, s39, 106496
  s_add_u32 s37, s40, 172032
  buffer_load_dwordx4 v1, s[12:15], s37 offen nt lds
  buffer_load_dwordx4 v2, s[12:15], s37 offen offset:1024 nt lds
  s_add_u32 m0, s39, 114688
  s_add_u32 s37, s40, 32768
  buffer_load_dwordx4 v3, s[16:19], s37 offen nt lds
  buffer_load_dwordx4 v4, s[16:19], s37 offen offset:1024 nt lds
  s_add_u32 m0, s39, 122880
  s_add_u32 s37, s40, 163840
  buffer_load_dwordx4 v3, s[16:19], s37 offen nt lds
  buffer_load_dwordx4 v4, s[16:19], s37 offen offset:1024 nt lds
  v_pk_mul_f32 v[32:33], v[32:33], s[48:49]
  v_pk_mul_f32 v[34:35], v[34:35], s[48:49]
  v_cvt_pk_bf16_f32 v184, v32, v33
  v_cvt_pk_bf16_f32 v185, v34, v35
  v_pk_mul_f32 v[48:49], v[48:49], s[48:49]
  v_pk_mul_f32 v[50:51], v[50:51], s[48:49]
  v_cvt_pk_bf16_f32 v186, v48, v49
  v_cvt_pk_bf16_f32 v187, v50, v51
  v_accvgpr_write_b32 a0, v184
  v_accvgpr_write_b32 a1, v185
  v_accvgpr_write_b32 a2, v186
  v_accvgpr_write_b32 a3, v187
  v_pk_mul_f32 v[64:65], v[64:65], s[48:49]
  v_pk_mul_f32 v[66:67], v[66:67], s[48:49]
  v_cvt_pk_bf16_f32 v188, v64, v65
  v_cvt_pk_bf16_f32 v189, v66, v67
  v_pk_mul_f32 v[80:81], v[80:81], s[48:49]
  v_pk_mul_f32 v[82:83], v[82:83], s[48:49]
  v_cvt_pk_bf16_f32 v190, v80, v81
  v_cvt_pk_bf16_f32 v191, v82, v83
  v_accvgpr_write_b32 a4, v188
  v_accvgpr_write_b32 a5, v189
  v_accvgpr_write_b32 a6, v190
  v_accvgpr_write_b32 a7, v191
  v_pk_mul_f32 v[96:97], v[96:97], s[48:49]
  v_pk_mul_f32 v[98:99], v[98:99], s[48:49]
  v_cvt_pk_bf16_f32 v176, v96, v97
  v_cvt_pk_bf16_f32 v177, v98, v99
  v_pk_mul_f32 v[112:113], v[112:113], s[48:49]
  v_pk_mul_f32 v[114:115], v[114:115], s[48:49]
  v_cvt_pk_bf16_f32 v178, v112, v113
  v_cvt_pk_bf16_f32 v179, v114, v115
  v_accvgpr_write_b32 a8, v176
  v_accvgpr_write_b32 a9, v177
  v_accvgpr_write_b32 a10, v178
  v_accvgpr_write_b32 a11, v179
  v_pk_mul_f32 v[128:129], v[128:129], s[48:49]
  v_pk_mul_f32 v[130:131], v[130:131], s[48:49]
  v_cvt_pk_bf16_f32 v180, v128, v129
  v_cvt_pk_bf16_f32 v181, v130, v131
  v_pk_mul_f32 v[144:145], v[144:145], s[48:49]
  v_pk_mul_f32 v[146:147], v[146:147], s[48:49]
  v_cvt_pk_bf16_f32 v182, v144, v145
  v_cvt_pk_bf16_f32 v183, v146, v147
  v_accvgpr_write_b32 a12, v180
  v_accvgpr_write_b32 a13, v181
  v_accvgpr_write_b32 a14, v182
  v_accvgpr_write_b32 a15, v183
  v_pk_mul_f32 v[36:37], v[36:37], s[48:49]
  v_pk_mul_f32 v[38:39], v[38:39], s[48:49]
  v_cvt_pk_bf16_f32 v184, v36, v37
  v_cvt_pk_bf16_f32 v185, v38, v39
  v_pk_mul_f32 v[52:53], v[52:53], s[48:49]
  v_pk_mul_f32 v[54:55], v[54:55], s[48:49]
  v_cvt_pk_bf16_f32 v186, v52, v53
  v_cvt_pk_bf16_f32 v187, v54, v55
  v_accvgpr_write_b32 a16, v184
  v_accvgpr_write_b32 a17, v185
  v_accvgpr_write_b32 a18, v186
  v_accvgpr_write_b32 a19, v187
  v_pk_mul_f32 v[68:69], v[68:69], s[48:49]
  v_pk_mul_f32 v[70:71], v[70:71], s[48:49]
  v_cvt_pk_bf16_f32 v188, v68, v69
  v_cvt_pk_bf16_f32 v189, v70, v71
  v_pk_mul_f32 v[84:85], v[84:85], s[48:49]
  v_pk_mul_f32 v[86:87], v[86:87], s[48:49]
  v_cvt_pk_bf16_f32 v190, v84, v85
  v_cvt_pk_bf16_f32 v191, v86, v87
  v_accvgpr_write_b32 a20, v188
  v_accvgpr_write_b32 a21, v189
  v_accvgpr_write_b32 a22, v190
  v_accvgpr_write_b32 a23, v191
  v_pk_mul_f32 v[100:101], v[100:101], s[48:49]
  v_pk_mul_f32 v[102:103], v[102:103], s[48:49]
  v_cvt_pk_bf16_f32 v176, v100, v101
  v_cvt_pk_bf16_f32 v177, v102, v103
  v_pk_mul_f32 v[116:117], v[116:117], s[48:49]
  v_pk_mul_f32 v[118:119], v[118:119], s[48:49]
  v_cvt_pk_bf16_f32 v178, v116, v117
  v_cvt_pk_bf16_f32 v179, v118, v119
  v_accvgpr_write_b32 a24, v176
  v_accvgpr_write_b32 a25, v177
  v_accvgpr_write_b32 a26, v178
  v_accvgpr_write_b32 a27, v179
  v_pk_mul_f32 v[132:133], v[132:133], s[48:49]
  v_pk_mul_f32 v[134:135], v[134:135], s[48:49]
  v_cvt_pk_bf16_f32 v180, v132, v133
  v_cvt_pk_bf16_f32 v181, v134, v135
  v_pk_mul_f32 v[148:149], v[148:149], s[48:49]
  v_pk_mul_f32 v[150:151], v[150:151], s[48:49]
  v_cvt_pk_bf16_f32 v182, v148, v149
  v_cvt_pk_bf16_f32 v183, v150, v151
  v_accvgpr_write_b32 a28, v180
  v_accvgpr_write_b32 a29, v181
  v_accvgpr_write_b32 a30, v182
  v_accvgpr_write_b32 a31, v183
  v_pk_mul_f32 v[40:41], v[40:41], s[48:49]
  v_pk_mul_f32 v[42:43], v[42:43], s[48:49]
  v_cvt_pk_bf16_f32 v184, v40, v41
  v_cvt_pk_bf16_f32 v185, v42, v43
  v_pk_mul_f32 v[56:57], v[56:57], s[48:49]
  v_pk_mul_f32 v[58:59], v[58:59], s[48:49]
  v_cvt_pk_bf16_f32 v186, v56, v57
  v_cvt_pk_bf16_f32 v187, v58, v59
  v_accvgpr_write_b32 a32, v184
  v_accvgpr_write_b32 a33, v185
  v_accvgpr_write_b32 a34, v186
  v_accvgpr_write_b32 a35, v187
  v_pk_mul_f32 v[72:73], v[72:73], s[48:49]
  v_pk_mul_f32 v[74:75], v[74:75], s[48:49]
  v_cvt_pk_bf16_f32 v188, v72, v73
  v_cvt_pk_bf16_f32 v189, v74, v75
  v_pk_mul_f32 v[88:89], v[88:89], s[48:49]
  v_pk_mul_f32 v[90:91], v[90:91], s[48:49]
  v_cvt_pk_bf16_f32 v190, v88, v89
  v_cvt_pk_bf16_f32 v191, v90, v91
  v_accvgpr_write_b32 a36, v188
  v_accvgpr_write_b32 a37, v189
  v_accvgpr_write_b32 a38, v190
  v_accvgpr_write_b32 a39, v191
  v_pk_mul_f32 v[104:105], v[104:105], s[48:49]
  v_pk_mul_f32 v[106:107], v[106:107], s[48:49]
  v_cvt_pk_bf16_f32 v176, v104, v105
  v_cvt_pk_bf16_f32 v177, v106, v107
  v_pk_mul_f32 v[120:121], v[120:121], s[48:49]
  v_pk_mul_f32 v[122:123], v[122:123], s[48:49]
  v_cvt_pk_bf16_f32 v178, v120, v121
  v_cvt_pk_bf16_f32 v179, v122, v123
  v_accvgpr_write_b32 a40, v176
  v_accvgpr_write_b32 a41, v177
  v_accvgpr_write_b32 a42, v178
  v_accvgpr_write_b32 a43, v179
  v_pk_mul_f32 v[136:137], v[136:137], s[48:49]
  v_pk_mul_f32 v[138:139], v[138:139], s[48:49]
  v_cvt_pk_bf16_f32 v180, v136, v137
  v_cvt_pk_bf16_f32 v181, v138, v139
  v_pk_mul_f32 v[152:153], v[152:153], s[48:49]
  v_pk_mul_f32 v[154:155], v[154:155], s[48:49]
  v_cvt_pk_bf16_f32 v182, v152, v153
  v_cvt_pk_bf16_f32 v183, v154, v155
  v_accvgpr_write_b32 a44, v180
  v_accvgpr_write_b32 a45, v181
  v_accvgpr_write_b32 a46, v182
  v_accvgpr_write_b32 a47, v183
  v_pk_mul_f32 v[44:45], v[44:45], s[48:49]
  v_pk_mul_f32 v[46:47], v[46:47], s[48:49]
  v_cvt_pk_bf16_f32 v184, v44, v45
  v_cvt_pk_bf16_f32 v185, v46, v47
  v_pk_mul_f32 v[60:61], v[60:61], s[48:49]
  v_pk_mul_f32 v[62:63], v[62:63], s[48:49]
  v_cvt_pk_bf16_f32 v186, v60, v61
  v_cvt_pk_bf16_f32 v187, v62, v63
  v_accvgpr_write_b32 a48, v184
  v_accvgpr_write_b32 a49, v185
  v_accvgpr_write_b32 a50, v186
  v_accvgpr_write_b32 a51, v187
  v_pk_mul_f32 v[76:77], v[76:77], s[48:49]
  v_pk_mul_f32 v[78:79], v[78:79], s[48:49]
  v_cvt_pk_bf16_f32 v188, v76, v77
  v_cvt_pk_bf16_f32 v189, v78, v79
  v_pk_mul_f32 v[92:93], v[92:93], s[48:49]
  v_pk_mul_f32 v[94:95], v[94:95], s[48:49]
  v_cvt_pk_bf16_f32 v190, v92, v93
  v_cvt_pk_bf16_f32 v191, v94, v95
  v_accvgpr_write_b32 a52, v188
  v_accvgpr_write_b32 a53, v189
  v_accvgpr_write_b32 a54, v190
  v_accvgpr_write_b32 a55, v191
  v_pk_mul_f32 v[108:109], v[108:109], s[48:49]
  v_pk_mul_f32 v[110:111], v[110:111], s[48:49]
  v_cvt_pk_bf16_f32 v176, v108, v109
  v_cvt_pk_bf16_f32 v177, v110, v111
  v_pk_mul_f32 v[124:125], v[124:125], s[48:49]
  v_pk_mul_f32 v[126:127], v[126:127], s[48:49]
  v_cvt_pk_bf16_f32 v178, v124, v125
  v_cvt_pk_bf16_f32 v179, v126, v127
  v_accvgpr_write_b32 a56, v176
  v_accvgpr_write_b32 a57, v177
  v_accvgpr_write_b32 a58, v178
  v_accvgpr_write_b32 a59, v179
  v_pk_mul_f32 v[140:141], v[140:141], s[48:49]
  v_pk_mul_f32 v[142:143], v[142:143], s[48:49]
  v_cvt_pk_bf16_f32 v180, v140, v141
  v_cvt_pk_bf16_f32 v181, v142, v143
  v_pk_mul_f32 v[156:157], v[156:157], s[48:49]
  v_pk_mul_f32 v[158:159], v[158:159], s[48:49]
  v_cvt_pk_bf16_f32 v182, v156, v157
  v_cvt_pk_bf16_f32 v183, v158, v159
  v_accvgpr_write_b32 a60, v180
  v_accvgpr_write_b32 a61, v181
  v_accvgpr_write_b32 a62, v182
  v_accvgpr_write_b32 a63, v183
  v_mov_b32 v236, 0
  v_mov_b32 v237, 0
  v_mov_b32 v238, 0
  v_mov_b32 v239, 0
  v_mov_b32 v240, 0
  v_mov_b32 v241, 0
  v_mov_b32 v242, 0
  v_mov_b32 v243, 0
  v_mov_b32 v244, 0
  v_mov_b32 v245, 0
  v_mov_b32 v246, 0
  v_mov_b32 v247, 0
  v_mov_b32 v248, 0
  v_mov_b32 v249, 0
  v_mov_b32 v250, 0
  v_mov_b32 v251, 0
  v_mov_b32 v252, 0
  v_mov_b32 v253, 0
  v_mov_b32 v254, 0
  v_mov_b32 v255, 0
  s_and_b32 s46, s2, 3
  s_bfe_u32 s47, s2, 0x20003
  s_lshl_b32 s26, s47, 2
  s_lshl_b32 s52, s46, 20
  s_lshl_b32 s53, s47, 8
  s_add_u32 s52, s52, s53
  s_add_u32 s8, s98, s52
  s_addc_u32 s9, s99, 0
  s_sub_u32 s10, 0x400000, s52
  s_mov_b32 s11, 0x20000
  v_lshrrev_b32 v27, 4, v0
  v_lshlrev_b32 v28, 2, v27
  v_and_b32 v29, 15, v0
  v_xor_b32 v28, v28, v29
  v_lshlrev_b32 v28, 4, v28
  s_lshl_b32 s52, s3, 4
  v_add_u32 v27, s52, v27
  v_lshl_add_u32 v19, v27, 10, v28
  v_add_u32 v23, 3072, v19
  v_add_u32 v24, 6144, v19
  v_add_u32 v25, 9216, v19
  v_lshlrev_b32 v27, 4, v0
  v_add_u32 v20, s45, v27
  v_add_u32 v22, 65536, v27
  v_add_u32 v26, 102400, v27
  v_lshrrev_b32 v27, 4, v0
  v_bfe_u32 v28, v0, 2, 2
  v_lshl_add_u32 v27, v27, 2, v28
  v_lshlrev_b32 v28, 2, v28
  v_and_b32 v29, 3, v0
  s_lshl_b32 s52, s3, 2
  v_add_u32 v29, s52, v29
  v_xor_b32 v28, v28, v29
  v_lshlrev_b32 v28, 4, v28
  v_lshl_add_u32 v21, v27, 8, v28
  s_cmp_eq_u32 s2, 0
  s_cbranch_scc0 concat_heads__gqa_block_cached__mha_block_cached__near_ridge_kernel_nonce15
  s_cmp_eq_u32 s3, 0
  s_cbranch_scc0 concat_heads__gqa_block_cached__mha_block_cached__near_ridge_kernel_nonce15
  s_memrealtime s[88:89]
  s_waitcnt lgkmcnt(0)
  s_or_b32 s88, s88, 1
  v_mov_b32 v30, s88
  v_mov_b32 v31, s89
  v_mov_b32 v29, 0
  s_mov_b64 exec, 1
  s_nop 4
  global_store_dwordx2 v29, v[30:31], s[86:87] sc1
  s_mov_b64 exec, -1
concat_heads__gqa_block_cached__mha_block_cached__near_ridge_kernel_nonce15:
  s_mov_b32 s51, 0
concat_heads__gqa_block_cached__mha_block_cached__near_ridge_kernel_attn:
  v_mov_b32 v28, 0x3f803f80
  v_mov_b32 v29, 0x3f803f80
  v_mov_b32 v30, 0x3f803f80
  v_mov_b32 v31, 0x3f803f80
  v_mov_b32 v32, 0
  v_mov_b32 v33, 0
  v_mov_b32 v34, 0
  v_mov_b32 v35, 0
  v_mov_b32 v36, 0
  v_mov_b32 v37, 0
  v_mov_b32 v38, 0
  v_mov_b32 v39, 0
  v_mov_b32 v40, 0
  v_mov_b32 v41, 0
  v_mov_b32 v42, 0
  v_mov_b32 v43, 0
  v_mov_b32 v44, 0
  v_mov_b32 v45, 0
  v_mov_b32 v46, 0
  v_mov_b32 v47, 0
  v_mov_b32 v48, 0
  v_mov_b32 v49, 0
  v_mov_b32 v50, 0
  v_mov_b32 v51, 0
  v_mov_b32 v52, 0
  v_mov_b32 v53, 0
  v_mov_b32 v54, 0
  v_mov_b32 v55, 0
  v_mov_b32 v56, 0
  v_mov_b32 v57, 0
  v_mov_b32 v58, 0
  v_mov_b32 v59, 0
  v_mov_b32 v60, 0
  v_mov_b32 v61, 0
  v_mov_b32 v62, 0
  v_mov_b32 v63, 0
  v_mov_b32 v64, 0
  v_mov_b32 v65, 0
  v_mov_b32 v66, 0
  v_mov_b32 v67, 0
  v_mov_b32 v68, 0
  v_mov_b32 v69, 0
  v_mov_b32 v70, 0
  v_mov_b32 v71, 0
  v_mov_b32 v72, 0
  v_mov_b32 v73, 0
  v_mov_b32 v74, 0
  v_mov_b32 v75, 0
  v_mov_b32 v76, 0
  v_mov_b32 v77, 0
  v_mov_b32 v78, 0
  v_mov_b32 v79, 0
  v_mov_b32 v80, 0
  v_mov_b32 v81, 0
  v_mov_b32 v82, 0
  v_mov_b32 v83, 0
  v_mov_b32 v84, 0
  v_mov_b32 v85, 0
  v_mov_b32 v86, 0
  v_mov_b32 v87, 0
  v_mov_b32 v88, 0
  v_mov_b32 v89, 0
  v_mov_b32 v90, 0
  v_mov_b32 v91, 0
  v_mov_b32 v92, 0
  v_mov_b32 v93, 0
  v_mov_b32 v94, 0
  v_mov_b32 v95, 0
  v_mov_b32 v96, 0
  v_mov_b32 v97, 0
  v_mov_b32 v98, 0
  v_mov_b32 v99, 0
  v_mov_b32 v100, 0
  v_mov_b32 v101, 0
  v_mov_b32 v102, 0
  v_mov_b32 v103, 0
  v_mov_b32 v104, 0
  v_mov_b32 v105, 0
  v_mov_b32 v106, 0
  v_mov_b32 v107, 0
  v_mov_b32 v108, 0
  v_mov_b32 v109, 0
  v_mov_b32 v110, 0
  v_mov_b32 v111, 0
  v_mov_b32 v112, 0
  v_mov_b32 v113, 0
  v_mov_b32 v114, 0
  v_mov_b32 v115, 0
  v_mov_b32 v116, 0
  v_mov_b32 v117, 0
  v_mov_b32 v118, 0
  v_mov_b32 v119, 0
  v_mov_b32 v120, 0
  v_mov_b32 v121, 0
  v_mov_b32 v122, 0
  v_mov_b32 v123, 0
  v_mov_b32 v124, 0
  v_mov_b32 v125, 0
  v_mov_b32 v126, 0
  v_mov_b32 v127, 0
  v_mov_b32 v128, 0
  v_mov_b32 v129, 0
  v_mov_b32 v130, 0
  v_mov_b32 v131, 0
  v_mov_b32 v132, 0
  v_mov_b32 v133, 0
  v_mov_b32 v134, 0
  v_mov_b32 v135, 0
  v_mov_b32 v136, 0
  v_mov_b32 v137, 0
  v_mov_b32 v138, 0
  v_mov_b32 v139, 0
  v_mov_b32 v140, 0
  v_mov_b32 v141, 0
  v_mov_b32 v142, 0
  v_mov_b32 v143, 0
  v_mov_b32 v144, 0
  v_mov_b32 v145, 0
  v_mov_b32 v146, 0
  v_mov_b32 v147, 0
  v_mov_b32 v148, 0
  v_mov_b32 v149, 0
  v_mov_b32 v150, 0
  v_mov_b32 v151, 0
  v_mov_b32 v152, 0
  v_mov_b32 v153, 0
  v_mov_b32 v154, 0
  v_mov_b32 v155, 0
  v_mov_b32 v156, 0
  v_mov_b32 v157, 0
  v_mov_b32 v158, 0
  v_mov_b32 v159, 0
  v_mov_b32 v160, 0
  v_mov_b32 v161, 0
  v_mov_b32 v162, 0
  v_mov_b32 v163, 0
  v_mov_b32 v164, 0
  v_mov_b32 v165, 0
  v_mov_b32 v166, 0
  v_mov_b32 v167, 0
  v_mov_b32 v168, 0
  v_mov_b32 v169, 0
  v_mov_b32 v170, 0
  v_mov_b32 v171, 0
  v_mov_b32 v172, 0
  v_mov_b32 v173, 0
  v_mov_b32 v174, 0
  v_mov_b32 v175, 0
  v_mov_b32 v176, 0
  v_mov_b32 v177, 0
  v_mov_b32 v178, 0
  v_mov_b32 v179, 0
  v_mov_b32 v180, 0
  v_mov_b32 v181, 0
  v_mov_b32 v182, 0
  v_mov_b32 v183, 0
  v_mov_b32 v184, 0
  v_mov_b32 v185, 0
  v_mov_b32 v186, 0
  v_mov_b32 v187, 0
  v_mov_b32 v188, 0
  v_mov_b32 v189, 0
  v_mov_b32 v190, 0
  v_mov_b32 v191, 0
  v_mov_b32 v216, 0
  v_mov_b32 v217, 0
  v_mov_b32 v218, 0
  v_mov_b32 v219, 0
  v_mov_b32 v220, 0
  v_mov_b32 v221, 0
  v_mov_b32 v222, 0
  v_mov_b32 v223, 0
  v_mov_b32 v224, 0
  v_mov_b32 v225, 0
  v_mov_b32 v226, 0
  v_mov_b32 v227, 0
  v_mov_b32 v228, 0
  v_mov_b32 v229, 0
  v_mov_b32 v230, 0
  v_mov_b32 v231, 0
  v_mov_b32 v232, 0
  v_mov_b32 v233, 0
  v_mov_b32 v234, 0
  v_mov_b32 v235, 0
  v_accvgpr_write_b32 a80, 0
  v_accvgpr_write_b32 a81, 0
  v_accvgpr_write_b32 a82, 0
  v_accvgpr_write_b32 a83, 0
  v_accvgpr_write_b32 a84, 0
  v_accvgpr_write_b32 a85, 0
  v_accvgpr_write_b32 a86, 0
  v_accvgpr_write_b32 a87, 0
  v_accvgpr_write_b32 a88, 0
  v_accvgpr_write_b32 a89, 0
  v_accvgpr_write_b32 a90, 0
  v_accvgpr_write_b32 a91, 0
  v_accvgpr_write_b32 a92, 0
  v_accvgpr_write_b32 a93, 0
  v_accvgpr_write_b32 a94, 0
  v_accvgpr_write_b32 a95, 0
  v_accvgpr_write_b32 a96, 0
  v_accvgpr_write_b32 a97, 0
  v_accvgpr_write_b32 a98, 0
  v_accvgpr_write_b32 a99, 0
  s_cmp_eq_u32 s24, 0
  s_cbranch_scc0 concat_heads__gqa_block_cached__mha_block_cached__near_ridge_kernel_vz16
  v_accvgpr_write_b32 a196, 0
  v_accvgpr_write_b32 a197, 0
  v_accvgpr_write_b32 a198, 0
  v_accvgpr_write_b32 a199, 0
  v_accvgpr_write_b32 a200, 0
  v_accvgpr_write_b32 a201, 0
  v_accvgpr_write_b32 a202, 0
  v_accvgpr_write_b32 a203, 0
  v_accvgpr_write_b32 a204, 0
  v_accvgpr_write_b32 a205, 0
  v_accvgpr_write_b32 a206, 0
  v_accvgpr_write_b32 a207, 0
  v_accvgpr_write_b32 a208, 0
  v_accvgpr_write_b32 a209, 0
  v_accvgpr_write_b32 a210, 0
  v_accvgpr_write_b32 a211, 0
  v_accvgpr_write_b32 a212, 0
  v_accvgpr_write_b32 a213, 0
  v_accvgpr_write_b32 a214, 0
  v_accvgpr_write_b32 a215, 0
  v_accvgpr_write_b32 a216, 0
  v_accvgpr_write_b32 a217, 0
  v_accvgpr_write_b32 a218, 0
  v_accvgpr_write_b32 a219, 0
  v_accvgpr_write_b32 a220, 0
  v_accvgpr_write_b32 a221, 0
  v_accvgpr_write_b32 a222, 0
  v_accvgpr_write_b32 a223, 0
  v_accvgpr_write_b32 a224, 0
  v_accvgpr_write_b32 a225, 0
  v_accvgpr_write_b32 a226, 0
  v_accvgpr_write_b32 a227, 0
  s_branch concat_heads__gqa_block_cached__mha_block_cached__near_ridge_kernel_vzd17
concat_heads__gqa_block_cached__mha_block_cached__near_ridge_kernel_vz16:
  v_accvgpr_write_b32 a164, 0
  v_accvgpr_write_b32 a165, 0
  v_accvgpr_write_b32 a166, 0
  v_accvgpr_write_b32 a167, 0
  v_accvgpr_write_b32 a168, 0
  v_accvgpr_write_b32 a169, 0
  v_accvgpr_write_b32 a170, 0
  v_accvgpr_write_b32 a171, 0
  v_accvgpr_write_b32 a172, 0
  v_accvgpr_write_b32 a173, 0
  v_accvgpr_write_b32 a174, 0
  v_accvgpr_write_b32 a175, 0
  v_accvgpr_write_b32 a176, 0
  v_accvgpr_write_b32 a177, 0
  v_accvgpr_write_b32 a178, 0
  v_accvgpr_write_b32 a179, 0
  v_accvgpr_write_b32 a180, 0
  v_accvgpr_write_b32 a181, 0
  v_accvgpr_write_b32 a182, 0
  v_accvgpr_write_b32 a183, 0
  v_accvgpr_write_b32 a184, 0
  v_accvgpr_write_b32 a185, 0
  v_accvgpr_write_b32 a186, 0
  v_accvgpr_write_b32 a187, 0
  v_accvgpr_write_b32 a188, 0
  v_accvgpr_write_b32 a189, 0
  v_accvgpr_write_b32 a190, 0
  v_accvgpr_write_b32 a191, 0
  v_accvgpr_write_b32 a192, 0
  v_accvgpr_write_b32 a193, 0
  v_accvgpr_write_b32 a194, 0
  v_accvgpr_write_b32 a195, 0
concat_heads__gqa_block_cached__mha_block_cached__near_ridge_kernel_vzd17:
  v_mov_b32 v200, 0xff800000
  v_mov_b32 v201, 0xff800000
  v_mov_b32 v202, 0xff800000
  v_mov_b32 v203, 0xff800000
  v_mov_b32 v204, 0xff800000
  v_mov_b32 v205, 0xff800000
  v_mov_b32 v206, 0xff800000
  v_mov_b32 v207, 0xff800000
  s_mov_b32 s30, 0
  s_mov_b32 s35, 3
  s_lshl_b32 s41, s26, 16
  s_lshl_b32 s42, s3, 12
  s_mov_b32 s43, 15838
  s_mov_b32 s44, 7646
  s_add_u32 s31, s39, 131072
  s_add_u32 s32, s40, 49152
  s_add_u32 s33, s40, 40960
  s_cmp_eq_u32 s24, 0
  s_cbranch_scc0 concat_heads__gqa_block_cached__mha_block_cached__near_ridge_kernel_bodyB
concat_heads__gqa_block_cached__mha_block_cached__near_ridge_kernel_bodyA:
  s_sub_u32 s48, s30, 6
  s_cmp_le_u32 s48, 3
  s_cbranch_scc1 concat_heads__gqa_block_cached__mha_block_cached__near_ridge_kernel_A19
  s_cmp_le_u32 s30, 0
  s_cbranch_scc1 concat_heads__gqa_block_cached__mha_block_cached__near_ridge_kernel_A20
  s_cmp_le_u32 s30, 3
  s_cbranch_scc1 concat_heads__gqa_block_cached__mha_block_cached__near_ridge_kernel_A21
  s_cmp_le_u32 s30, 5
  s_cbranch_scc1 concat_heads__gqa_block_cached__mha_block_cached__near_ridge_kernel_A22
  s_cmp_le_u32 s30, 13
  s_cbranch_scc1 concat_heads__gqa_block_cached__mha_block_cached__near_ridge_kernel_A23
  s_cmp_le_u32 s30, 14
  s_cbranch_scc1 concat_heads__gqa_block_cached__mha_block_cached__near_ridge_kernel_A24
  s_waitcnt vmcnt(14)
  s_branch concat_heads__gqa_block_cached__mha_block_cached__near_ridge_kernel_Ad18
concat_heads__gqa_block_cached__mha_block_cached__near_ridge_kernel_A19:
  s_waitcnt vmcnt(16)
  s_branch concat_heads__gqa_block_cached__mha_block_cached__near_ridge_kernel_Ad18
concat_heads__gqa_block_cached__mha_block_cached__near_ridge_kernel_A20:
  s_waitcnt vmcnt(8)
  s_branch concat_heads__gqa_block_cached__mha_block_cached__near_ridge_kernel_Ad18
concat_heads__gqa_block_cached__mha_block_cached__near_ridge_kernel_A21:
  s_waitcnt vmcnt(48)
  s_branch concat_heads__gqa_block_cached__mha_block_cached__near_ridge_kernel_Ad18
concat_heads__gqa_block_cached__mha_block_cached__near_ridge_kernel_A22:
  s_waitcnt vmcnt(24)
  s_branch concat_heads__gqa_block_cached__mha_block_cached__near_ridge_kernel_Ad18
concat_heads__gqa_block_cached__mha_block_cached__near_ridge_kernel_A23:
  s_waitcnt vmcnt(8)
  s_branch concat_heads__gqa_block_cached__mha_block_cached__near_ridge_kernel_Ad18
concat_heads__gqa_block_cached__mha_block_cached__near_ridge_kernel_A24:
  s_waitcnt vmcnt(10)
concat_heads__gqa_block_cached__mha_block_cached__near_ridge_kernel_Ad18:
  s_waitcnt lgkmcnt(0)
  s_barrier
  v_mfma_f32_16x16x32_bf16 v[192:195], a[100:103], a[0:3], v[236:239]
  s_bitcmp1_b32 s44, s30
  s_cbranch_scc0 concat_heads__gqa_block_cached__mha_block_cached__near_ridge_kernel_g25
  s_add_u32 m0, s31, 0
  s_add_u32 s37, s32, 0
  buffer_load_dwordx4 v1, s[12:15], s37 offen nt lds
  buffer_load_dwordx4 v2, s[12:15], s37 offen offset:1024 nt lds
concat_heads__gqa_block_cached__mha_block_cached__near_ridge_kernel_g25:
  v_mfma_f32_16x16x32_bf16 v[196:199], a[116:119], a[0:3], v[236:239]
  s_add_u32 s35, s35, 1
  s_cmp_eq_u32 s35, 5
  s_mov_b32 s34, 32768
  s_cmov_b32 s34, -131072
  s_cselect_b32 s35, 0, s35
  v_mfma_f32_16x16x32_bf16 v[192:195], a[104:107], a[4:7], v[192:195]
  v_add_u32 v5, s34, v5
  v_mfma_f32_16x16x32_bf16 v[196:199], a[120:123], a[4:7], v[196:199]
  v_add_u32 v6, s34, v6
  v_mfma_f32_16x16x32_bf16 v[192:195], a[108:111], a[8:11], v[192:195]
  v_add_u32 v7, s34, v7
  v_mfma_f32_16x16x32_bf16 v[196:199], a[124:127], a[8:11], v[196:199]
  v_add_u32 v8, s34, v8
  v_mfma_f32_16x16x32_bf16 v[192:195], a[112:115], a[12:15], v[192:195]
  v_add_u32 v9, s34, v9
  v_mfma_f32_16x16x32_bf16 v[196:199], a[128:131], a[12:15], v[196:199]
  v_add_u32 v10, s34, v10
  v_mfma_f32_16x16x32_bf16 v[32:35], a[196:199], v[216:219], v[32:35]
  v_add_u32 v11, s34, v11
  v_add_u32 v12, s34, v12
  v_mfma_f32_16x16x32_bf16 v[48:51], a[200:203], v[216:219], v[48:51]
  v_add_u32 v13, s34, v13
  v_mfma_f32_16x16x32_bf16 v[64:67], a[204:207], v[216:219], v[64:67]
  v_add_u32 v14, s34, v14
  v_mfma_f32_16x16x32_bf16 v[80:83], a[208:211], v[216:219], v[80:83]
  v_add_u32 v15, s34, v15
  v_mfma_f32_16x16x32_bf16 v[96:99], a[212:215], v[216:219], v[96:99]
  v_add_u32 v16, s34, v16
  v_mfma_f32_16x16x32_bf16 v[112:115], a[216:219], v[216:219], v[112:115]
  ds_read_b128 a[132:135], v5 offset:0
  v_mfma_f32_16x16x32_bf16 v[128:131], a[220:223], v[216:219], v[128:131]
  ds_read_b128 a[136:139], v6 offset:0
  v_mfma_f32_16x16x32_bf16 v[144:147], a[224:227], v[216:219], v[144:147]
  ds_read_b128 a[140:143], v7 offset:0
  v_mfma_f32_16x16x32_bf16 a[80:83], v[28:31], v[216:219], a[80:83]
  ds_read_b128 a[144:147], v8 offset:0
  ds_read_b128 a[148:151], v5 offset:4096
  v_mfma_f32_16x16x32_bf16 v[200:203], a[100:103], a[16:19], v[240:243]
  v_exp_f32 v192, v192
  v_mfma_f32_16x16x32_bf16 v[204:207], a[116:119], a[16:19], v[240:243]
  ds_read_b128 a[152:155], v6 offset:4096
  v_mfma_f32_16x16x32_bf16 v[200:203], a[104:107], a[20:23], v[200:203]
  v_exp_f32 v193, v193
  v_mfma_f32_16x16x32_bf16 v[204:207], a[120:123], a[20:23], v[204:207]
  v_exp_f32 v194, v194
  v_mfma_f32_16x16x32_bf16 v[200:203], a[108:111], a[24:27], v[200:203]
  v_exp_f32 v195, v195
  v_mfma_f32_16x16x32_bf16 v[204:207], a[124:127], a[24:27], v[204:207]
  ds_read_b128 a[156:159], v7 offset:4096
  v_mfma_f32_16x16x32_bf16 v[200:203], a[112:115], a[28:31], v[200:203]
  v_exp_f32 v196, v196
  v_mfma_f32_16x16x32_bf16 v[204:207], a[128:131], a[28:31], v[204:207]
  v_exp_f32 v197, v197
  v_mfma_f32_16x16x32_bf16 v[36:39], a[196:199], v[220:223], v[36:39]
  ds_read_b128 a[160:163], v8 offset:4096
  v_mfma_f32_16x16x32_bf16 v[52:55], a[200:203], v[220:223], v[52:55]
  s_bitcmp1_b32 s44, s30
  s_cbranch_scc0 concat_heads__gqa_block_cached__mha_block_cached__near_ridge_kernel_g26
  s_add_u32 m0, s31, 8192
  s_add_u32 s37, s32, 131072
  buffer_load_dwordx4 v1, s[12:15], s37 offen nt lds
  buffer_load_dwordx4 v2, s[12:15], s37 offen offset:1024 nt lds
concat_heads__gqa_block_cached__mha_block_cached__near_ridge_kernel_g26:
  v_mfma_f32_16x16x32_bf16 v[68:71], a[204:207], v[220:223], v[68:71]
  v_exp_f32 v198, v198
  v_mfma_f32_16x16x32_bf16 v[84:87], a[208:211], v[220:223], v[84:87]
  v_exp_f32 v199, v199
  v_mfma_f32_16x16x32_bf16 v[100:103], a[212:215], v[220:223], v[100:103]
  ds_read_b64_tr_b16 a[164:165], v9
  v_mfma_f32_16x16x32_bf16 v[116:119], a[216:219], v[220:223], v[116:119]
  v_cvt_pk_bf16_f32 v216, v192, v193
  v_mfma_f32_16x16x32_bf16 v[132:135], a[220:223], v[220:223], v[132:135]
  v_cvt_pk_bf16_f32 v217, v194, v195
  v_mfma_f32_16x16x32_bf16 v[148:151], a[224:227], v[220:223], v[148:151]
  v_cvt_pk_bf16_f32 v218, v196, v197
  v_mfma_f32_16x16x32_bf16 a[84:87], v[28:31], v[220:223], a[84:87]
  ds_read_b64_tr_b16 a[166:167], v9 offset:4096
  v_cvt_pk_bf16_f32 v219, v198, v199
  v_mfma_f32_16x16x32_bf16 v[208:211], a[100:103], a[32:35], v[244:247]
  v_exp_f32 v200, v200
  v_mfma_f32_16x16x32_bf16 v[212:215], a[116:119], a[32:35], v[244:247]
  ds_read_b64_tr_b16 a[168:169], v10
  v_mfma_f32_16x16x32_bf16 v[208:211], a[104:107], a[36:39], v[208:211]
  v_exp_f32 v201, v201
  v_mfma_f32_16x16x32_bf16 v[212:215], a[120:123], a[36:39], v[212:215]
  v_exp_f32 v202, v202
  v_mfma_f32_16x16x32_bf16 v[208:211], a[108:111], a[40:43], v[208:211]
  v_exp_f32 v203, v203
  v_mfma_f32_16x16x32_bf16 v[212:215], a[124:127], a[40:43], v[212:215]
  ds_read_b64_tr_b16 a[170:171], v10 offset:4096
  v_mfma_f32_16x16x32_bf16 v[208:211], a[112:115], a[44:47], v[208:211]
  v_exp_f32 v204, v204
  v_mfma_f32_16x16x32_bf16 v[212:215], a[128:131], a[44:47], v[212:215]
  v_exp_f32 v205, v205
  v_mfma_f32_16x16x32_bf16 v[40:43], a[196:199], v[224:227], v[40:43]
  ds_read_b64_tr_b16 a[172:173], v11
  v_mfma_f32_16x16x32_bf16 v[56:59], a[200:203], v[224:227], v[56:59]
  s_bitcmp1_b32 s43, s30
  s_cbranch_scc0 concat_heads__gqa_block_cached__mha_block_cached__near_ridge_kernel_g27
  s_add_u32 m0, s31, 16384
  s_add_u32 s37, s33, 0
  buffer_load_dwordx4 v3, s[16:19], s37 offen nt lds
  buffer_load_dwordx4 v4, s[16:19], s37 offen offset:1024 nt lds
concat_heads__gqa_block_cached__mha_block_cached__near_ridge_kernel_g27:
  v_mfma_f32_16x16x32_bf16 v[72:75], a[204:207], v[224:227], v[72:75]
  v_exp_f32 v206, v206
  v_mfma_f32_16x16x32_bf16 v[88:91], a[208:211], v[224:227], v[88:91]
  v_exp_f32 v207, v207
  v_mfma_f32_16x16x32_bf16 v[104:107], a[212:215], v[224:227], v[104:107]
  ds_read_b64_tr_b16 a[174:175], v11 offset:4096
  v_mfma_f32_16x16x32_bf16 v[120:123], a[216:219], v[224:227], v[120:123]
  v_cvt_pk_bf16_f32 v220, v200, v201
  v_mfma_f32_16x16x32_bf16 v[136:139], a[220:223], v[224:227], v[136:139]
  v_cvt_pk_bf16_f32 v221, v202, v203
  v_mfma_f32_16x16x32_bf16 v[152:155], a[224:227], v[224:227], v[152:155]
  v_cvt_pk_bf16_f32 v222, v204, v205
  v_mfma_f32_16x16x32_bf16 a[88:91], v[28:31], v[224:227], a[88:91]
  ds_read_b64_tr_b16 a[176:177], v12
  v_cvt_pk_bf16_f32 v223, v206, v207
  v_mfma_f32_16x16x32_bf16 v[192:195], a[100:103], a[48:51], v[248:251]
  v_exp_f32 v208, v208
  v_mfma_f32_16x16x32_bf16 v[196:199], a[116:119], a[48:51], v[248:251]
  s_waitcnt lgkmcnt(7)
  ds_read_b64_tr_b16 a[178:179], v12 offset:4096
  v_mfma_f32_16x16x32_bf16 v[192:195], a[104:107], a[52:55], v[192:195]
  v_exp_f32 v209, v209
  v_mfma_f32_16x16x32_bf16 v[196:199], a[120:123], a[52:55], v[196:199]
  v_exp_f32 v210, v210
  v_mfma_f32_16x16x32_bf16 v[192:195], a[108:111], a[56:59], v[192:195]
  v_exp_f32 v211, v211
  v_mfma_f32_16x16x32_bf16 v[196:199], a[124:127], a[56:59], v[196:199]
  ds_read_b64_tr_b16 a[180:181], v13
  v_mfma_f32_16x16x32_bf16 v[192:195], a[112:115], a[60:63], v[192:195]
  v_exp_f32 v212, v212
  v_mfma_f32_16x16x32_bf16 v[196:199], a[128:131], a[60:63], v[196:199]
  v_exp_f32 v213, v213
  v_mfma_f32_16x16x32_bf16 v[44:47], a[196:199], v[228:231], v[44:47]
  ds_read_b64_tr_b16 a[182:183], v13 offset:4096
  v_mfma_f32_16x16x32_bf16 v[60:63], a[200:203], v[228:231], v[60:63]
  s_bitcmp1_b32 s43, s30
  s_cbranch_scc0 concat_heads__gqa_block_cached__mha_block_cached__near_ridge_kernel_g28
  s_add_u32 m0, s31, 24576
  s_add_u32 s37, s33, 131072
  buffer_load_dwordx4 v3, s[16:19], s37 offen nt lds
  buffer_load_dwordx4 v4, s[16:19], s37 offen offset:1024 nt lds
  s_add_u32 s32, s32, 8192
  s_add_u32 s33, s33, 8192
  s_add_u32 s31, s31, 32768
  s_add_u32 s48, s39, 163840
  s_cmp_ge_u32 s31, s48
  s_cselect_b32 s48, 163840, 0
  s_sub_u32 s31, s31, s48
concat_heads__gqa_block_cached__mha_block_cached__near_ridge_kernel_g28:
  v_mfma_f32_16x16x32_bf16 v[76:79], a[204:207], v[228:231], v[76:79]
  v_exp_f32 v214, v214
  v_mfma_f32_16x16x32_bf16 v[92:95], a[208:211], v[228:231], v[92:95]
  v_exp_f32 v215, v215
  v_mfma_f32_16x16x32_bf16 v[108:111], a[212:215], v[228:231], v[108:111]
  ds_read_b64_tr_b16 a[184:185], v14
  v_mfma_f32_16x16x32_bf16 v[124:127], a[216:219], v[228:231], v[124:127]
  v_cvt_pk_bf16_f32 v224, v208, v209
  v_mfma_f32_16x16x32_bf16 v[140:143], a[220:223], v[228:231], v[140:143]
  v_cvt_pk_bf16_f32 v225, v210, v211
  v_mfma_f32_16x16x32_bf16 v[156:159], a[224:227], v[228:231], v[156:159]
  v_cvt_pk_bf16_f32 v226, v212, v213
  v_mfma_f32_16x16x32_bf16 a[92:95], v[28:31], v[228:231], a[92:95]
  ds_read_b64_tr_b16 a[186:187], v14 offset:4096
  v_cvt_pk_bf16_f32 v227, v214, v215
  v_mfma_f32_16x16x32_bf16 v[200:203], a[100:103], a[64:67], v[252:255]
  v_exp_f32 v192, v192
  v_exp_f32 v193, v193
  v_mfma_f32_16x16x32_bf16 v[204:207], a[116:119], a[64:67], v[252:255]
  ds_read_b64_tr_b16 a[188:189], v15
  v_exp_f32 v194, v194
  v_mfma_f32_16x16x32_bf16 v[200:203], a[104:107], a[68:71], v[200:203]
  v_exp_f32 v195, v195
  v_exp_f32 v196, v196
  v_mfma_f32_16x16x32_bf16 v[204:207], a[120:123], a[68:71], v[204:207]
  ds_read_b64_tr_b16 a[190:191], v15 offset:4096
  v_exp_f32 v197, v197
  v_mfma_f32_16x16x32_bf16 v[200:203], a[108:111], a[72:75], v[200:203]
  s_cmp_eq_u32 s30, 13
  s_cbranch_scc0 concat_heads__gqa_block_cached__mha_block_cached__near_ridge_kernel_g30
  s_add_u32 s36, s26, 4
  s_add_u32 s36, s36, s28
  s_and_b32 s36, s36, 15
  s_lshl_b32 s36, s36, 16
  buffer_load_dwordx4 a[228:231], v19, s[8:11], s36 offen offset:0
  buffer_load_dwordx4 a[232:235], v23, s[8:11], s36 offen offset:1024
  buffer_load_dwordx4 a[236:239], v24, s[8:11], s36 offen offset:2048
  buffer_load_dwordx4 a[240:243], v25, s[8:11], s36 offen offset:3072
  s_lshr_b32 s36, s28, 1
  s_add_u32 s36, s36, s26
  s_add_u32 s36, s36, 12
  s_and_b32 s36, s36, 15
  s_lshl_b32 s36, s36, 16
  s_and_b32 s37, s28, 1
  s_lshl_b32 s37, s37, 13
  s_add_u32 s36, s36, s37
  buffer_load_dwordx4 a[244:247], v19, s[8:11], s36 offen offset:0
  buffer_load_dwordx4 a[248:251], v23, s[8:11], s36 offen offset:1024
concat_heads__gqa_block_cached__mha_block_cached__near_ridge_kernel_g30:
  s_cmp_ge_u32 s30, 14
  s_cbranch_scc0 concat_heads__gqa_block_cached__mha_block_cached__near_ridge_kernel_g29
  s_add_u32 m0, s42, 0
  s_add_u32 s36, s41, 0
  buffer_load_dwordx4 v19, s[8:11], s36 offen  lds
  buffer_load_dwordx4 v23, s[8:11], s36 offen offset:1024  lds
  buffer_load_dwordx4 v24, s[8:11], s36 offen offset:2048  lds
  buffer_load_dwordx4 v25, s[8:11], s36 offen offset:3072  lds
  s_add_u32 m0, s42, 16384
  s_add_u32 s36, s41, 65536
  buffer_load_dwordx4 v19, s[8:11], s36 offen  lds
  buffer_load_dwordx4 v23, s[8:11], s36 offen offset:1024  lds
  buffer_load_dwordx4 v24, s[8:11], s36 offen offset:2048  lds
  buffer_load_dwordx4 v25, s[8:11], s36 offen offset:3072  lds
  s_add_u32 s41, s41, 131072
  s_add_u32 s42, s42, 32768
concat_heads__gqa_block_cached__mha_block_cached__near_ridge_kernel_g29:
  v_exp_f32 v198, v198
  v_mfma_f32_16x16x32_bf16 v[204:207], a[124:127], a[72:75], v[204:207]
  v_exp_f32 v199, v199
  ds_read_b64_tr_b16 a[192:193], v16
  v_mfma_f32_16x16x32_bf16 v[200:203], a[112:115], a[76:79], v[200:203]
  v_cvt_pk_bf16_f32 v228, v192, v193
  v_cvt_pk_bf16_f32 v229, v194, v195
  v_mfma_f32_16x16x32_bf16 v[204:207], a[128:131], a[76:79], v[204:207]
  v_cvt_pk_bf16_f32 v230, v196, v197
  s_waitcnt lgkmcnt(7)
  ds_read_b64_tr_b16 a[194:195], v16 offset:4096
  v_cvt_pk_bf16_f32 v231, v198, v199
  s_add_u32 s30, s30, 1
  s_cmp_eq_u32 s30, 16
  s_cbranch_scc1 concat_heads__gqa_block_cached__mha_block_cached__near_ridge_kernel_endB
concat_heads__gqa_block_cached__mha_block_cached__near_ridge_kernel_bodyB:
  s_sub_u32 s48, s30, 6
  s_cmp_le_u32 s48, 3
  s_cbranch_scc1 concat_heads__gqa_block_cached__mha_block_cached__near_ridge_kernel_B32
  s_cmp_le_u32 s30, 0
  s_cbranch_scc1 concat_heads__gqa_block_cached__mha_block_cached__near_ridge_kernel_B33
  s_cmp_le_u32 s30, 3
  s_cbranch_scc1 concat_heads__gqa_block_cached__mha_block_cached__near_ridge_kernel_B34
  s_cmp_le_u32 s30, 5
  s_cbranch_scc1 concat_heads__gqa_block_cached__mha_block_cached__near_ridge_kernel_B35
  s_cmp_le_u32 s30, 13
  s_cbranch_scc1 concat_heads__gqa_block_cached__mha_block_cached__near_ridge_kernel_B36
  s_cmp_le_u32 s30, 14
  s_cbranch_scc1 concat_heads__gqa_block_cached__mha_block_cached__near_ridge_kernel_B37
  s_waitcnt vmcnt(14)
  s_branch concat_heads__gqa_block_cached__mha_block_cached__near_ridge_kernel_Bd31
concat_heads__gqa_block_cached__mha_block_cached__near_ridge_kernel_B32:
  s_waitcnt vmcnt(16)
  s_branch concat_heads__gqa_block_cached__mha_block_cached__near_ridge_kernel_Bd31
concat_heads__gqa_block_cached__mha_block_cached__near_ridge_kernel_B33:
  s_waitcnt vmcnt(8)
  s_branch concat_heads__gqa_block_cached__mha_block_cached__near_ridge_kernel_Bd31
concat_heads__gqa_block_cached__mha_block_cached__near_ridge_kernel_B34:
  s_waitcnt vmcnt(48)
  s_branch concat_heads__gqa_block_cached__mha_block_cached__near_ridge_kernel_Bd31
concat_heads__gqa_block_cached__mha_block_cached__near_ridge_kernel_B35:
  s_waitcnt vmcnt(24)
  s_branch concat_heads__gqa_block_cached__mha_block_cached__near_ridge_kernel_Bd31
concat_heads__gqa_block_cached__mha_block_cached__near_ridge_kernel_B36:
  s_waitcnt vmcnt(8)
  s_branch concat_heads__gqa_block_cached__mha_block_cached__near_ridge_kernel_Bd31
concat_heads__gqa_block_cached__mha_block_cached__near_ridge_kernel_B37:
  s_waitcnt vmcnt(10)
concat_heads__gqa_block_cached__mha_block_cached__near_ridge_kernel_Bd31:
  s_waitcnt lgkmcnt(0)
  s_barrier
  v_mfma_f32_16x16x32_bf16 v[208:211], a[132:135], a[0:3], v[236:239]
  s_bitcmp1_b32 s44, s30
  s_cbranch_scc0 concat_heads__gqa_block_cached__mha_block_cached__near_ridge_kernel_g38
  s_add_u32 m0, s31, 0
  s_add_u32 s37, s32, 0
  buffer_load_dwordx4 v1, s[12:15], s37 offen nt lds
  buffer_load_dwordx4 v2, s[12:15], s37 offen offset:1024 nt lds
concat_heads__gqa_block_cached__mha_block_cached__near_ridge_kernel_g38:
  v_mfma_f32_16x16x32_bf16 v[212:215], a[148:151], a[0:3], v[236:239]
  s_add_u32 s35, s35, 1
  s_cmp_eq_u32 s35, 5
  s_mov_b32 s34, 32768
  s_cmov_b32 s34, -131072
  s_cselect_b32 s35, 0, s35
  v_add_u32 v5, s34, v5
  v_mfma_f32_16x16x32_bf16 v[208:211], a[136:139], a[4:7], v[208:211]
  v_add_u32 v6, s34, v6
  v_add_u32 v7, s34, v7
  v_mfma_f32_16x16x32_bf16 v[212:215], a[152:155], a[4:7], v[212:215]
  v_add_u32 v8, s34, v8
  v_add_u32 v9, s34, v9
  v_mfma_f32_16x16x32_bf16 v[208:211], a[140:143], a[8:11], v[208:211]
  v_add_u32 v10, s34, v10
  v_add_u32 v11, s34, v11
  v_mfma_f32_16x16x32_bf16 v[212:215], a[156:159], a[8:11], v[212:215]
  v_add_u32 v12, s34, v12
  v_mfma_f32_16x16x32_bf16 v[208:211], a[144:147], a[12:15], v[208:211]
  v_add_u32 v13, s34, v13
  v_add_u32 v14, s34, v14
  v_mfma_f32_16x16x32_bf16 v[212:215], a[160:163], a[12:15], v[212:215]
  v_add_u32 v15, s34, v15
  v_add_u32 v16, s34, v16
  v_mfma_f32_16x16x32_bf16 v[32:35], a[164:167], v[216:219], v[32:35]
  v_exp_f32 v200, v200
  v_exp_f32 v201, v201
  v_mfma_f32_16x16x32_bf16 v[48:51], a[168:171], v[216:219], v[48:51]
  v_exp_f32 v202, v202
  v_exp_f32 v203, v203
  v_mfma_f32_16x16x32_bf16 v[64:67], a[172:175], v[216:219], v[64:67]
  v_exp_f32 v204, v204
  v_exp_f32 v205, v205
  v_mfma_f32_16x16x32_bf16 v[80:83], a[176:179], v[216:219], v[80:83]
  v_exp_f32 v206, v206
  v_mfma_f32_16x16x32_bf16 v[96:99], a[180:183], v[216:219], v[96:99]
  v_exp_f32 v207, v207
  v_cvt_pk_bf16_f32 v232, v200, v201
  v_mfma_f32_16x16x32_bf16 v[112:115], a[184:187], v[216:219], v[112:115]
  v_cvt_pk_bf16_f32 v233, v202, v203
  v_cvt_pk_bf16_f32 v234, v204, v205
  v_mfma_f32_16x16x32_bf16 v[128:131], a[188:191], v[216:219], v[128:131]
  v_cvt_pk_bf16_f32 v235, v206, v207
  ds_read_b128 a[100:103], v5 offset:0
  v_mfma_f32_16x16x32_bf16 v[144:147], a[192:195], v[216:219], v[144:147]
  ds_read_b128 a[104:107], v6 offset:0
  ds_read_b128 a[108:111], v7 offset:0
  v_mfma_f32_16x16x32_bf16 a[80:83], v[28:31], v[216:219], a[80:83]
  ds_read_b128 a[112:115], v8 offset:0
  ds_read_b128 a[116:119], v5 offset:4096
  v_mfma_f32_16x16x32_bf16 v[192:195], a[132:135], a[16:19], v[240:243]
  v_exp_f32 v208, v208
  v_mfma_f32_16x16x32_bf16 v[196:199], a[148:151], a[16:19], v[240:243]
  ds_read_b128 a[120:123], v6 offset:4096
  v_mfma_f32_16x16x32_bf16 v[192:195], a[136:139], a[20:23], v[192:195]
  v_exp_f32 v209, v209
  v_mfma_f32_16x16x32_bf16 v[196:199], a[152:155], a[20:23], v[196:199]
  v_exp_f32 v210, v210
  v_mfma_f32_16x16x32_bf16 v[192:195], a[140:143], a[24:27], v[192:195]
  v_exp_f32 v211, v211
  v_mfma_f32_16x16x32_bf16 v[196:199], a[156:159], a[24:27], v[196:199]
  ds_read_b128 a[124:127], v7 offset:4096
  v_mfma_f32_16x16x32_bf16 v[192:195], a[144:147], a[28:31], v[192:195]
  v_exp_f32 v212, v212
  v_mfma_f32_16x16x32_bf16 v[196:199], a[160:163], a[28:31], v[196:199]
  v_exp_f32 v213, v213
  v_mfma_f32_16x16x32_bf16 v[36:39], a[164:167], v[220:223], v[36:39]
  ds_read_b128 a[128:131], v8 offset:4096
  v_mfma_f32_16x16x32_bf16 v[52:55], a[168:171], v[220:223], v[52:55]
  s_bitcmp1_b32 s44, s30
  s_cbranch_scc0 concat_heads__gqa_block_cached__mha_block_cached__near_ridge_kernel_g39
  s_add_u32 m0, s31, 8192
  s_add_u32 s37, s32, 131072
  buffer_load_dwordx4 v1, s[12:15], s37 offen nt lds
  buffer_load_dwordx4 v2, s[12:15], s37 offen offset:1024 nt lds
concat_heads__gqa_block_cached__mha_block_cached__near_ridge_kernel_g39:
  v_mfma_f32_16x16x32_bf16 v[68:71], a[172:175], v[220:223], v[68:71]
  v_exp_f32 v214, v214
  v_mfma_f32_16x16x32_bf16 v[84:87], a[176:179], v[220:223], v[84:87]
  v_exp_f32 v215, v215
  v_mfma_f32_16x16x32_bf16 v[100:103], a[180:183], v[220:223], v[100:103]
  ds_read_b64_tr_b16 a[196:197], v9
  v_mfma_f32_16x16x32_bf16 v[116:119], a[184:187], v[220:223], v[116:119]
  v_cvt_pk_bf16_f32 v216, v208, v209
  v_mfma_f32_16x16x32_bf16 v[132:135], a[188:191], v[220:223], v[132:135]
  v_cvt_pk_bf16_f32 v217, v210, v211
  v_mfma_f32_16x16x32_bf16 v[148:151], a[192:195], v[220:223], v[148:151]
  v_cvt_pk_bf16_f32 v218, v212, v213
  v_mfma_f32_16x16x32_bf16 a[84:87], v[28:31], v[220:223], a[84:87]
  ds_read_b64_tr_b16 a[198:199], v9 offset:4096
  v_cvt_pk_bf16_f32 v219, v214, v215
  v_mfma_f32_16x16x32_bf16 v[200:203], a[132:135], a[32:35], v[244:247]
  v_exp_f32 v192, v192
  v_mfma_f32_16x16x32_bf16 v[204:207], a[148:151], a[32:35], v[244:247]
  ds_read_b64_tr_b16 a[200:201], v10
  v_mfma_f32_16x16x32_bf16 v[200:203], a[136:139], a[36:39], v[200:203]
  v_exp_f32 v193, v193
  v_mfma_f32_16x16x32_bf16 v[204:207], a[152:155], a[36:39], v[204:207]
  v_exp_f32 v194, v194
  v_mfma_f32_16x16x32_bf16 v[200:203], a[140:143], a[40:43], v[200:203]
  v_exp_f32 v195, v195
  v_mfma_f32_16x16x32_bf16 v[204:207], a[156:159], a[40:43], v[204:207]
  ds_read_b64_tr_b16 a[202:203], v10 offset:4096
  v_mfma_f32_16x16x32_bf16 v[200:203], a[144:147], a[44:47], v[200:203]
  v_exp_f32 v196, v196
  v_mfma_f32_16x16x32_bf16 v[204:207], a[160:163], a[44:47], v[204:207]
  v_exp_f32 v197, v197
  v_mfma_f32_16x16x32_bf16 v[40:43], a[164:167], v[224:227], v[40:43]
  ds_read_b64_tr_b16 a[204:205], v11
  v_mfma_f32_16x16x32_bf16 v[56:59], a[168:171], v[224:227], v[56:59]
  s_bitcmp1_b32 s43, s30
  s_cbranch_scc0 concat_heads__gqa_block_cached__mha_block_cached__near_ridge_kernel_g40
  s_add_u32 m0, s31, 16384
  s_add_u32 s37, s33, 0
  buffer_load_dwordx4 v3, s[16:19], s37 offen nt lds
  buffer_load_dwordx4 v4, s[16:19], s37 offen offset:1024 nt lds
concat_heads__gqa_block_cached__mha_block_cached__near_ridge_kernel_g40:
  v_mfma_f32_16x16x32_bf16 v[72:75], a[172:175], v[224:227], v[72:75]
  v_exp_f32 v198, v198
  v_mfma_f32_16x16x32_bf16 v[88:91], a[176:179], v[224:227], v[88:91]
  v_exp_f32 v199, v199
  v_mfma_f32_16x16x32_bf16 v[104:107], a[180:183], v[224:227], v[104:107]
  ds_read_b64_tr_b16 a[206:207], v11 offset:4096
  v_mfma_f32_16x16x32_bf16 v[120:123], a[184:187], v[224:227], v[120:123]
  v_cvt_pk_bf16_f32 v220, v192, v193
  v_mfma_f32_16x16x32_bf16 v[136:139], a[188:191], v[224:227], v[136:139]
  v_cvt_pk_bf16_f32 v221, v194, v195
  v_mfma_f32_16x16x32_bf16 v[152:155], a[192:195], v[224:227], v[152:155]
  v_cvt_pk_bf16_f32 v222, v196, v197
  v_mfma_f32_16x16x32_bf16 a[88:91], v[28:31], v[224:227], a[88:91]
  ds_read_b64_tr_b16 a[208:209], v12
  v_cvt_pk_bf16_f32 v223, v198, v199
  v_mfma_f32_16x16x32_bf16 v[208:211], a[132:135], a[48:51], v[248:251]
  v_exp_f32 v200, v200
  v_mfma_f32_16x16x32_bf16 v[212:215], a[148:151], a[48:51], v[248:251]
  s_waitcnt lgkmcnt(7)
  ds_read_b64_tr_b16 a[210:211], v12 offset:4096
  v_mfma_f32_16x16x32_bf16 v[208:211], a[136:139], a[52:55], v[208:211]
  v_exp_f32 v201, v201
  v_mfma_f32_16x16x32_bf16 v[212:215], a[152:155], a[52:55], v[212:215]
  v_exp_f32 v202, v202
  v_mfma_f32_16x16x32_bf16 v[208:211], a[140:143], a[56:59], v[208:211]
  v_exp_f32 v203, v203
  v_mfma_f32_16x16x32_bf16 v[212:215], a[156:159], a[56:59], v[212:215]
  ds_read_b64_tr_b16 a[212:213], v13
  v_mfma_f32_16x16x32_bf16 v[208:211], a[144:147], a[60:63], v[208:211]
  v_exp_f32 v204, v204
  v_mfma_f32_16x16x32_bf16 v[212:215], a[160:163], a[60:63], v[212:215]
  v_exp_f32 v205, v205
  v_mfma_f32_16x16x32_bf16 v[44:47], a[164:167], v[228:231], v[44:47]
  ds_read_b64_tr_b16 a[214:215], v13 offset:4096
  v_mfma_f32_16x16x32_bf16 v[60:63], a[168:171], v[228:231], v[60:63]
  s_bitcmp1_b32 s43, s30
  s_cbranch_scc0 concat_heads__gqa_block_cached__mha_block_cached__near_ridge_kernel_g41
  s_add_u32 m0, s31, 24576
  s_add_u32 s37, s33, 131072
  buffer_load_dwordx4 v3, s[16:19], s37 offen nt lds
  buffer_load_dwordx4 v4, s[16:19], s37 offen offset:1024 nt lds
  s_add_u32 s32, s32, 8192
  s_add_u32 s33, s33, 8192
  s_add_u32 s31, s31, 32768
  s_add_u32 s48, s39, 163840
  s_cmp_ge_u32 s31, s48
  s_cselect_b32 s48, 163840, 0
  s_sub_u32 s31, s31, s48
concat_heads__gqa_block_cached__mha_block_cached__near_ridge_kernel_g41:
  v_mfma_f32_16x16x32_bf16 v[76:79], a[172:175], v[228:231], v[76:79]
  v_exp_f32 v206, v206
  v_mfma_f32_16x16x32_bf16 v[92:95], a[176:179], v[228:231], v[92:95]
  v_exp_f32 v207, v207
  v_mfma_f32_16x16x32_bf16 v[108:111], a[180:183], v[228:231], v[108:111]
  ds_read_b64_tr_b16 a[216:217], v14
  v_mfma_f32_16x16x32_bf16 v[124:127], a[184:187], v[228:231], v[124:127]
  v_cvt_pk_bf16_f32 v224, v200, v201
  v_mfma_f32_16x16x32_bf16 v[140:143], a[188:191], v[228:231], v[140:143]
  v_cvt_pk_bf16_f32 v225, v202, v203
  v_mfma_f32_16x16x32_bf16 v[156:159], a[192:195], v[228:231], v[156:159]
  v_cvt_pk_bf16_f32 v226, v204, v205
  v_mfma_f32_16x16x32_bf16 a[92:95], v[28:31], v[228:231], a[92:95]
  ds_read_b64_tr_b16 a[218:219], v14 offset:4096
  v_cvt_pk_bf16_f32 v227, v206, v207
  v_mfma_f32_16x16x32_bf16 v[160:163], a[164:167], v[232:235], v[160:163]
  v_exp_f32 v208, v208
  v_mfma_f32_16x16x32_bf16 v[164:167], a[168:171], v[232:235], v[164:167]
  v_exp_f32 v209, v209
  ds_read_b64_tr_b16 a[220:221], v15
  v_mfma_f32_16x16x32_bf16 v[168:171], a[172:175], v[232:235], v[168:171]
  v_exp_f32 v210, v210
  v_exp_f32 v211, v211
  v_mfma_f32_16x16x32_bf16 v[172:175], a[176:179], v[232:235], v[172:175]
  v_exp_f32 v212, v212
  ds_read_b64_tr_b16 a[222:223], v15 offset:4096
  v_mfma_f32_16x16x32_bf16 v[176:179], a[180:183], v[232:235], v[176:179]
  v_exp_f32 v213, v213
  s_cmp_eq_u32 s30, 13
  s_cbranch_scc0 concat_heads__gqa_block_cached__mha_block_cached__near_ridge_kernel_g43
  s_add_u32 s36, s26, 4
  s_add_u32 s36, s36, s28
  s_and_b32 s36, s36, 15
  s_lshl_b32 s36, s36, 16
  buffer_load_dwordx4 a[228:231], v19, s[8:11], s36 offen offset:0
  buffer_load_dwordx4 a[232:235], v23, s[8:11], s36 offen offset:1024
  buffer_load_dwordx4 a[236:239], v24, s[8:11], s36 offen offset:2048
  buffer_load_dwordx4 a[240:243], v25, s[8:11], s36 offen offset:3072
  s_lshr_b32 s36, s28, 1
  s_add_u32 s36, s36, s26
  s_add_u32 s36, s36, 12
  s_and_b32 s36, s36, 15
  s_lshl_b32 s36, s36, 16
  s_and_b32 s37, s28, 1
  s_lshl_b32 s37, s37, 13
  s_add_u32 s36, s36, s37
  buffer_load_dwordx4 a[244:247], v19, s[8:11], s36 offen offset:0
  buffer_load_dwordx4 a[248:251], v23, s[8:11], s36 offen offset:1024
concat_heads__gqa_block_cached__mha_block_cached__near_ridge_kernel_g43:
  s_cmp_ge_u32 s30, 14
  s_cbranch_scc0 concat_heads__gqa_block_cached__mha_block_cached__near_ridge_kernel_g42
  s_add_u32 m0, s42, 0
  s_add_u32 s36, s41, 0
  buffer_load_dwordx4 v19, s[8:11], s36 offen  lds
  buffer_load_dwordx4 v23, s[8:11], s36 offen offset:1024  lds
  buffer_load_dwordx4 v24, s[8:11], s36 offen offset:2048  lds
  buffer_load_dwordx4 v25, s[8:11], s36 offen offset:3072  lds
  s_add_u32 m0, s42, 16384
  s_add_u32 s36, s41, 65536
  buffer_load_dwordx4 v19, s[8:11], s36 offen  lds
  buffer_load_dwordx4 v23, s[8:11], s36 offen offset:1024  lds
  buffer_load_dwordx4 v24, s[8:11], s36 offen offset:2048  lds
  buffer_load_dwordx4 v25, s[8:11], s36 offen offset:3072  lds
  s_add_u32 s41, s41, 131072
  s_add_u32 s42, s42, 32768
concat_heads__gqa_block_cached__mha_block_cached__near_ridge_kernel_g42:
  v_mfma_f32_16x16x32_bf16 v[180:183], a[184:187], v[232:235], v[180:183]
  v_exp_f32 v214, v214
  v_exp_f32 v215, v215
  v_mfma_f32_16x16x32_bf16 v[184:187], a[188:191], v[232:235], v[184:187]
  ds_read_b64_tr_b16 a[224:225], v16
  v_cvt_pk_bf16_f32 v228, v208, v209
  v_mfma_f32_16x16x32_bf16 v[188:191], a[192:195], v[232:235], v[188:191]
  v_cvt_pk_bf16_f32 v229, v210, v211
  v_cvt_pk_bf16_f32 v230, v212, v213
  v_mfma_f32_16x16x32_bf16 a[96:99], v[28:31], v[232:235], a[96:99]
  s_waitcnt lgkmcnt(7)
  ds_read_b64_tr_b16 a[226:227], v16 offset:4096
  v_cvt_pk_bf16_f32 v231, v214, v215
  s_add_u32 s30, s30, 1
  s_cmp_eq_u32 s30, 16
  s_cbranch_scc0 concat_heads__gqa_block_cached__mha_block_cached__near_ridge_kernel_bodyA
  s_waitcnt lgkmcnt(0)
  s_barrier
  v_mfma_f32_16x16x32_bf16 v[32:35], a[196:199], v[216:219], v[32:35]
  v_mfma_f32_16x16x32_bf16 v[48:51], a[200:203], v[216:219], v[48:51]
  v_mfma_f32_16x16x32_bf16 v[64:67], a[204:207], v[216:219], v[64:67]
  v_mfma_f32_16x16x32_bf16 v[80:83], a[208:211], v[216:219], v[80:83]
  v_mfma_f32_16x16x32_bf16 v[96:99], a[212:215], v[216:219], v[96:99]
  v_mfma_f32_16x16x32_bf16 v[112:115], a[216:219], v[216:219], v[112:115]
  v_mfma_f32_16x16x32_bf16 v[128:131], a[220:223], v[216:219], v[128:131]
  v_mfma_f32_16x16x32_bf16 v[144:147], a[224:227], v[216:219], v[144:147]
  v_mfma_f32_16x16x32_bf16 a[80:83], v[28:31], v[216:219], a[80:83]
  v_mfma_f32_16x16x32_bf16 v[36:39], a[196:199], v[220:223], v[36:39]
  v_mfma_f32_16x16x32_bf16 v[52:55], a[200:203], v[220:223], v[52:55]
  v_mfma_f32_16x16x32_bf16 v[68:71], a[204:207], v[220:223], v[68:71]
  v_mfma_f32_16x16x32_bf16 v[84:87], a[208:211], v[220:223], v[84:87]
  v_mfma_f32_16x16x32_bf16 v[100:103], a[212:215], v[220:223], v[100:103]
  v_mfma_f32_16x16x32_bf16 v[116:119], a[216:219], v[220:223], v[116:119]
  v_mfma_f32_16x16x32_bf16 v[132:135], a[220:223], v[220:223], v[132:135]
  v_mfma_f32_16x16x32_bf16 v[148:151], a[224:227], v[220:223], v[148:151]
  v_mfma_f32_16x16x32_bf16 a[84:87], v[28:31], v[220:223], a[84:87]
  v_mfma_f32_16x16x32_bf16 v[40:43], a[196:199], v[224:227], v[40:43]
  v_mfma_f32_16x16x32_bf16 v[56:59], a[200:203], v[224:227], v[56:59]
  v_mfma_f32_16x16x32_bf16 v[72:75], a[204:207], v[224:227], v[72:75]
  v_mfma_f32_16x16x32_bf16 v[88:91], a[208:211], v[224:227], v[88:91]
  v_mfma_f32_16x16x32_bf16 v[104:107], a[212:215], v[224:227], v[104:107]
  v_mfma_f32_16x16x32_bf16 v[120:123], a[216:219], v[224:227], v[120:123]
  v_mfma_f32_16x16x32_bf16 v[136:139], a[220:223], v[224:227], v[136:139]
  v_mfma_f32_16x16x32_bf16 v[152:155], a[224:227], v[224:227], v[152:155]
  v_mfma_f32_16x16x32_bf16 a[88:91], v[28:31], v[224:227], a[88:91]
  v_mfma_f32_16x16x32_bf16 v[44:47], a[196:199], v[228:231], v[44:47]
  v_mfma_f32_16x16x32_bf16 v[60:63], a[200:203], v[228:231], v[60:63]
  v_mfma_f32_16x16x32_bf16 v[76:79], a[204:207], v[228:231], v[76:79]
  v_mfma_f32_16x16x32_bf16 v[92:95], a[208:211], v[228:231], v[92:95]
  v_mfma_f32_16x16x32_bf16 v[108:111], a[212:215], v[228:231], v[108:111]
  v_mfma_f32_16x16x32_bf16 v[124:127], a[216:219], v[228:231], v[124:127]
  v_mfma_f32_16x16x32_bf16 v[140:143], a[220:223], v[228:231], v[140:143]
  v_mfma_f32_16x16x32_bf16 v[156:159], a[224:227], v[228:231], v[156:159]
  v_mfma_f32_16x16x32_bf16 a[92:95], v[28:31], v[228:231], a[92:95]
  s_branch concat_heads__gqa_block_cached__mha_block_cached__near_ridge_kernel_epi
concat_heads__gqa_block_cached__mha_block_cached__near_ridge_kernel_endB:
  s_waitcnt lgkmcnt(0)
  s_barrier
  v_mfma_f32_16x16x32_bf16 v[32:35], a[164:167], v[216:219], v[32:35]
  v_exp_f32 v200, v200
  v_mfma_f32_16x16x32_bf16 v[48:51], a[168:171], v[216:219], v[48:51]
  v_exp_f32 v201, v201
  v_mfma_f32_16x16x32_bf16 v[64:67], a[172:175], v[216:219], v[64:67]
  v_exp_f32 v202, v202
  v_exp_f32 v203, v203
  v_mfma_f32_16x16x32_bf16 v[80:83], a[176:179], v[216:219], v[80:83]
  v_exp_f32 v204, v204
  v_mfma_f32_16x16x32_bf16 v[96:99], a[180:183], v[216:219], v[96:99]
  v_exp_f32 v205, v205
  v_mfma_f32_16x16x32_bf16 v[112:115], a[184:187], v[216:219], v[112:115]
  v_exp_f32 v206, v206
  v_exp_f32 v207, v207
  v_mfma_f32_16x16x32_bf16 v[128:131], a[188:191], v[216:219], v[128:131]
  v_cvt_pk_bf16_f32 v232, v200, v201
  v_mfma_f32_16x16x32_bf16 v[144:147], a[192:195], v[216:219], v[144:147]
  v_cvt_pk_bf16_f32 v233, v202, v203
  v_mfma_f32_16x16x32_bf16 a[80:83], v[28:31], v[216:219], a[80:83]
  v_cvt_pk_bf16_f32 v234, v204, v205
  v_cvt_pk_bf16_f32 v235, v206, v207
  v_mfma_f32_16x16x32_bf16 v[36:39], a[164:167], v[220:223], v[36:39]
  v_mfma_f32_16x16x32_bf16 v[52:55], a[168:171], v[220:223], v[52:55]
  v_mfma_f32_16x16x32_bf16 v[68:71], a[172:175], v[220:223], v[68:71]
  v_mfma_f32_16x16x32_bf16 v[84:87], a[176:179], v[220:223], v[84:87]
  v_mfma_f32_16x16x32_bf16 v[100:103], a[180:183], v[220:223], v[100:103]
  v_mfma_f32_16x16x32_bf16 v[116:119], a[184:187], v[220:223], v[116:119]
  v_mfma_f32_16x16x32_bf16 v[132:135], a[188:191], v[220:223], v[132:135]
  v_mfma_f32_16x16x32_bf16 v[148:151], a[192:195], v[220:223], v[148:151]
  v_mfma_f32_16x16x32_bf16 a[84:87], v[28:31], v[220:223], a[84:87]
  v_mfma_f32_16x16x32_bf16 v[40:43], a[164:167], v[224:227], v[40:43]
  v_mfma_f32_16x16x32_bf16 v[56:59], a[168:171], v[224:227], v[56:59]
  v_mfma_f32_16x16x32_bf16 v[72:75], a[172:175], v[224:227], v[72:75]
  v_mfma_f32_16x16x32_bf16 v[88:91], a[176:179], v[224:227], v[88:91]
  v_mfma_f32_16x16x32_bf16 v[104:107], a[180:183], v[224:227], v[104:107]
  v_mfma_f32_16x16x32_bf16 v[120:123], a[184:187], v[224:227], v[120:123]
  v_mfma_f32_16x16x32_bf16 v[136:139], a[188:191], v[224:227], v[136:139]
  v_mfma_f32_16x16x32_bf16 v[152:155], a[192:195], v[224:227], v[152:155]
  v_mfma_f32_16x16x32_bf16 a[88:91], v[28:31], v[224:227], a[88:91]
  v_mfma_f32_16x16x32_bf16 v[44:47], a[164:167], v[228:231], v[44:47]
  v_mfma_f32_16x16x32_bf16 v[60:63], a[168:171], v[228:231], v[60:63]
  v_mfma_f32_16x16x32_bf16 v[76:79], a[172:175], v[228:231], v[76:79]
  v_mfma_f32_16x16x32_bf16 v[92:95], a[176:179], v[228:231], v[92:95]
  v_mfma_f32_16x16x32_bf16 v[108:111], a[180:183], v[228:231], v[108:111]
  v_mfma_f32_16x16x32_bf16 v[124:127], a[184:187], v[228:231], v[124:127]
  v_mfma_f32_16x16x32_bf16 v[140:143], a[188:191], v[228:231], v[140:143]
  v_mfma_f32_16x16x32_bf16 v[156:159], a[192:195], v[228:231], v[156:159]
  v_mfma_f32_16x16x32_bf16 a[92:95], v[28:31], v[228:231], a[92:95]
  v_mfma_f32_16x16x32_bf16 v[160:163], a[164:167], v[232:235], v[160:163]
  v_mfma_f32_16x16x32_bf16 v[164:167], a[168:171], v[232:235], v[164:167]
  v_mfma_f32_16x16x32_bf16 v[168:171], a[172:175], v[232:235], v[168:171]
  v_mfma_f32_16x16x32_bf16 v[172:175], a[176:179], v[232:235], v[172:175]
  v_mfma_f32_16x16x32_bf16 v[176:179], a[180:183], v[232:235], v[176:179]
  v_mfma_f32_16x16x32_bf16 v[180:183], a[184:187], v[232:235], v[180:183]
  v_mfma_f32_16x16x32_bf16 v[184:187], a[188:191], v[232:235], v[184:187]
  v_mfma_f32_16x16x32_bf16 v[188:191], a[192:195], v[232:235], v[188:191]
  v_mfma_f32_16x16x32_bf16 a[96:99], v[28:31], v[232:235], a[96:99]
concat_heads__gqa_block_cached__mha_block_cached__near_ridge_kernel_epi:
  s_mul_i32 s52, s3, 5120
  s_add_u32 s52, s52, 139264
  v_lshlrev_b32 v17, 4, v0
  v_add_u32 v27, s52, v17
  ds_write_b128 v27, v[176:179] offset:0
  ds_write_b128 v27, v[180:183] offset:1024
  ds_write_b128 v27, v[184:187] offset:2048
  ds_write_b128 v27, v[188:191] offset:3072
  ds_write_b128 v27, a[96:99] offset:4096
  s_cmp_eq_u32 s3, 0
  s_cbranch_scc0 concat_heads__gqa_block_cached__mha_block_cached__near_ridge_kernel_early44
  v_mov_b32 v27, 0
  global_load_dwordx2 v[240:241], v27, s[86:87] sc1
concat_heads__gqa_block_cached__mha_block_cached__near_ridge_kernel_early44:
  v_accvgpr_read_b32 v192, a80
  v_accvgpr_read_b32 v193, a84
  v_accvgpr_read_b32 v194, a88
  v_accvgpr_read_b32 v195, a92
  v_accvgpr_read_b32 v196, a96
  s_mov_b32 s52, 0x1f800000
  s_mov_b32 s53, 0x47800000
  s_lshl_b32 s36, s25, 1
  s_add_u32 s37, s36, s24
  s_mul_i32 s37, s37, 18432
  s_xor_b32 s48, s24, 1
  s_add_u32 s48, s48, s36
  s_mul_i32 s48, s48, 18432
  s_add_u32 s37, s37, 65536
  s_add_u32 s48, s48, 65536
  s_lshl_b32 s36, s24, 12
  v_add_u32 v31, s37, v17
  v_add_u32 v29, s36, v31
  s_add_u32 s48, s48, s36
  v_add_u32 v30, s48, v17
  s_add_u32 s36, s29, s25
  s_lshl_b32 s36, s36, 2
  s_lshl_b32 s37, s24, 1
  s_xor_b32 s48, s37, 0
  s_add_u32 s48, s48, s36
  s_mul_i32 s48, s48, 9216
  s_lshl_b32 s49, s24, 12
  s_add_u32 s42, s48, s49
  s_add_u32 s46, s48, 8192
  s_xor_b32 s48, s37, 1
  s_add_u32 s48, s48, s36
  s_mul_i32 s48, s48, 9216
  s_lshl_b32 s49, s24, 12
  s_add_u32 s43, s48, s49
  s_add_u32 s47, s48, 8192
  s_xor_b32 s48, s37, 2
  s_add_u32 s48, s48, s36
  s_mul_i32 s48, s48, 9216
  s_lshl_b32 s49, s24, 12
  s_add_u32 s44, s48, s49
  s_xor_b32 s48, s37, 3
  s_add_u32 s48, s48, s36
  s_mul_i32 s48, s48, 9216
  s_lshl_b32 s49, s24, 12
  s_add_u32 s45, s48, s49
  s_mov_b64 s[56:57], exec
  v_cmp_le_f32 vcc, s52, v192
  v_cmp_ge_f32 s[58:59], s53, v192
  v_rcp_f32 v192, v192
  s_nop 1
  s_and_b64 s[56:57], s[56:57], vcc
  s_and_b64 s[56:57], s[56:57], s[58:59]
  v_cmp_le_f32 vcc, s52, v193
  v_cmp_ge_f32 s[58:59], s53, v193
  v_rcp_f32 v193, v193
  s_nop 1
  s_and_b64 s[56:57], s[56:57], vcc
  s_and_b64 s[56:57], s[56:57], s[58:59]
  v_cmp_le_f32 vcc, s52, v194
  v_cmp_ge_f32 s[58:59], s53, v194
  v_rcp_f32 v194, v194
  s_nop 1
  s_and_b64 s[56:57], s[56:57], vcc
  s_and_b64 s[56:57], s[56:57], s[58:59]
  v_cmp_le_f32 vcc, s52, v195
  v_cmp_ge_f32 s[58:59], s53, v195
  v_rcp_f32 v195, v195
  s_nop 1
  s_and_b64 s[56:57], s[56:57], vcc
  s_and_b64 s[56:57], s[56:57], s[58:59]
  v_mov_b32 v201, v192
  v_mov_b32 v200, v192
  v_pk_mul_f32 v[32:33], v[32:33], v[200:201]
  v_pk_mul_f32 v[34:35], v[34:35], v[200:201]
  v_pk_mul_f32 v[48:49], v[48:49], v[200:201]
  v_pk_mul_f32 v[50:51], v[50:51], v[200:201]
  v_cvt_pk_bf16_f32 v32, v32, v33
  v_cvt_pk_bf16_f32 v33, v34, v35
  v_cvt_pk_bf16_f32 v34, v48, v49
  v_cvt_pk_bf16_f32 v35, v50, v51
  buffer_store_dwordx4 v[32:35], v17, s[20:23], s42 offen offset:0 sc1
  ds_write_b128 v29, v[32:35] offset:0
  v_pk_mul_f32 v[64:65], v[64:65], v[200:201]
  v_pk_mul_f32 v[66:67], v[66:67], v[200:201]
  v_pk_mul_f32 v[80:81], v[80:81], v[200:201]
  v_pk_mul_f32 v[82:83], v[82:83], v[200:201]
  v_cvt_pk_bf16_f32 v64, v64, v65
  v_cvt_pk_bf16_f32 v65, v66, v67
  v_cvt_pk_bf16_f32 v66, v80, v81
  v_cvt_pk_bf16_f32 v67, v82, v83
  buffer_store_dwordx4 v[64:67], v17, s[20:23], s43 offen offset:0 sc1
  ds_write_b128 v29, v[64:67] offset:9216
  v_pk_mul_f32 v[96:97], v[96:97], v[200:201]
  v_pk_mul_f32 v[98:99], v[98:99], v[200:201]
  v_pk_mul_f32 v[112:113], v[112:113], v[200:201]
  v_pk_mul_f32 v[114:115], v[114:115], v[200:201]
  v_cvt_pk_bf16_f32 v96, v96, v97
  v_cvt_pk_bf16_f32 v97, v98, v99
  v_cvt_pk_bf16_f32 v98, v112, v113
  v_cvt_pk_bf16_f32 v99, v114, v115
  buffer_store_dwordx4 v[96:99], v17, s[20:23], s44 offen offset:0 sc1
  ds_write_b128 v30, v[96:99] offset:0
  v_pk_mul_f32 v[128:129], v[128:129], v[200:201]
  v_pk_mul_f32 v[130:131], v[130:131], v[200:201]
  v_pk_mul_f32 v[144:145], v[144:145], v[200:201]
  v_pk_mul_f32 v[146:147], v[146:147], v[200:201]
  v_cvt_pk_bf16_f32 v128, v128, v129
  v_cvt_pk_bf16_f32 v129, v130, v131
  v_cvt_pk_bf16_f32 v130, v144, v145
  v_cvt_pk_bf16_f32 v131, v146, v147
  buffer_store_dwordx4 v[128:131], v17, s[20:23], s45 offen offset:0 sc1
  ds_write_b128 v30, v[128:131] offset:9216
  v_mov_b32 v201, v193
  v_mov_b32 v200, v193
  v_pk_mul_f32 v[36:37], v[36:37], v[200:201]
  v_pk_mul_f32 v[38:39], v[38:39], v[200:201]
  v_pk_mul_f32 v[52:53], v[52:53], v[200:201]
  v_pk_mul_f32 v[54:55], v[54:55], v[200:201]
  v_cvt_pk_bf16_f32 v36, v36, v37
  v_cvt_pk_bf16_f32 v37, v38, v39
  v_cvt_pk_bf16_f32 v38, v52, v53
  v_cvt_pk_bf16_f32 v39, v54, v55
  buffer_store_dwordx4 v[36:39], v17, s[20:23], s42 offen offset:1024 sc1
  ds_write_b128 v29, v[36:39] offset:1024
  v_pk_mul_f32 v[68:69], v[68:69], v[200:201]
  v_pk_mul_f32 v[70:71], v[70:71], v[200:201]
  v_pk_mul_f32 v[84:85], v[84:85], v[200:201]
  v_pk_mul_f32 v[86:87], v[86:87], v[200:201]
  v_cvt_pk_bf16_f32 v68, v68, v69
  v_cvt_pk_bf16_f32 v69, v70, v71
  v_cvt_pk_bf16_f32 v70, v84, v85
  v_cvt_pk_bf16_f32 v71, v86, v87
  buffer_store_dwordx4 v[68:71], v17, s[20:23], s43 offen offset:1024 sc1
  ds_write_b128 v29, v[68:71] offset:10240
  v_pk_mul_f32 v[100:101], v[100:101], v[200:201]
  v_pk_mul_f32 v[102:103], v[102:103], v[200:201]
  v_pk_mul_f32 v[116:117], v[116:117], v[200:201]
  v_pk_mul_f32 v[118:119], v[118:119], v[200:201]
  v_cvt_pk_bf16_f32 v100, v100, v101
  v_cvt_pk_bf16_f32 v101, v102, v103
  v_cvt_pk_bf16_f32 v102, v116, v117
  v_cvt_pk_bf16_f32 v103, v118, v119
  buffer_store_dwordx4 v[100:103], v17, s[20:23], s44 offen offset:1024 sc1
  ds_write_b128 v30, v[100:103] offset:1024
  v_pk_mul_f32 v[132:133], v[132:133], v[200:201]
  v_pk_mul_f32 v[134:135], v[134:135], v[200:201]
  v_pk_mul_f32 v[148:149], v[148:149], v[200:201]
  v_pk_mul_f32 v[150:151], v[150:151], v[200:201]
  v_cvt_pk_bf16_f32 v132, v132, v133
  v_cvt_pk_bf16_f32 v133, v134, v135
  v_cvt_pk_bf16_f32 v134, v148, v149
  v_cvt_pk_bf16_f32 v135, v150, v151
  buffer_store_dwordx4 v[132:135], v17, s[20:23], s45 offen offset:1024 sc1
  ds_write_b128 v30, v[132:135] offset:10240
  v_mov_b32 v201, v194
  v_mov_b32 v200, v194
  v_pk_mul_f32 v[40:41], v[40:41], v[200:201]
  v_pk_mul_f32 v[42:43], v[42:43], v[200:201]
  v_pk_mul_f32 v[56:57], v[56:57], v[200:201]
  v_pk_mul_f32 v[58:59], v[58:59], v[200:201]
  v_cvt_pk_bf16_f32 v40, v40, v41
  v_cvt_pk_bf16_f32 v41, v42, v43
  v_cvt_pk_bf16_f32 v42, v56, v57
  v_cvt_pk_bf16_f32 v43, v58, v59
  buffer_store_dwordx4 v[40:43], v17, s[20:23], s42 offen offset:2048 sc1
  ds_write_b128 v29, v[40:43] offset:2048
  v_pk_mul_f32 v[72:73], v[72:73], v[200:201]
  v_pk_mul_f32 v[74:75], v[74:75], v[200:201]
  v_pk_mul_f32 v[88:89], v[88:89], v[200:201]
  v_pk_mul_f32 v[90:91], v[90:91], v[200:201]
  v_cvt_pk_bf16_f32 v72, v72, v73
  v_cvt_pk_bf16_f32 v73, v74, v75
  v_cvt_pk_bf16_f32 v74, v88, v89
  v_cvt_pk_bf16_f32 v75, v90, v91
  buffer_store_dwordx4 v[72:75], v17, s[20:23], s43 offen offset:2048 sc1
  ds_write_b128 v29, v[72:75] offset:11264
  v_pk_mul_f32 v[104:105], v[104:105], v[200:201]
  v_pk_mul_f32 v[106:107], v[106:107], v[200:201]
  v_pk_mul_f32 v[120:121], v[120:121], v[200:201]
  v_pk_mul_f32 v[122:123], v[122:123], v[200:201]
  v_cvt_pk_bf16_f32 v104, v104, v105
  v_cvt_pk_bf16_f32 v105, v106, v107
  v_cvt_pk_bf16_f32 v106, v120, v121
  v_cvt_pk_bf16_f32 v107, v122, v123
  buffer_store_dwordx4 v[104:107], v17, s[20:23], s44 offen offset:2048 sc1
  s_waitcnt lgkmcnt(7)
  ds_write_b128 v30, v[104:107] offset:2048
  v_pk_mul_f32 v[136:137], v[136:137], v[200:201]
  v_pk_mul_f32 v[138:139], v[138:139], v[200:201]
  v_pk_mul_f32 v[152:153], v[152:153], v[200:201]
  v_pk_mul_f32 v[154:155], v[154:155], v[200:201]
  v_cvt_pk_bf16_f32 v136, v136, v137
  v_cvt_pk_bf16_f32 v137, v138, v139
  v_cvt_pk_bf16_f32 v138, v152, v153
  v_cvt_pk_bf16_f32 v139, v154, v155
  buffer_store_dwordx4 v[136:139], v17, s[20:23], s45 offen offset:2048 sc1
  ds_write_b128 v30, v[136:139] offset:11264
  v_mov_b32 v201, v195
  v_mov_b32 v200, v195
  v_pk_mul_f32 v[44:45], v[44:45], v[200:201]
  v_pk_mul_f32 v[46:47], v[46:47], v[200:201]
  v_pk_mul_f32 v[60:61], v[60:61], v[200:201]
  v_pk_mul_f32 v[62:63], v[62:63], v[200:201]
  v_cvt_pk_bf16_f32 v44, v44, v45
  v_cvt_pk_bf16_f32 v45, v46, v47
  v_cvt_pk_bf16_f32 v46, v60, v61
  v_cvt_pk_bf16_f32 v47, v62, v63
  buffer_store_dwordx4 v[44:47], v17, s[20:23], s42 offen offset:3072 sc1
  ds_write_b128 v29, v[44:47] offset:3072
  v_pk_mul_f32 v[76:77], v[76:77], v[200:201]
  v_pk_mul_f32 v[78:79], v[78:79], v[200:201]
  v_pk_mul_f32 v[92:93], v[92:93], v[200:201]
  v_pk_mul_f32 v[94:95], v[94:95], v[200:201]
  v_cvt_pk_bf16_f32 v76, v76, v77
  v_cvt_pk_bf16_f32 v77, v78, v79
  v_cvt_pk_bf16_f32 v78, v92, v93
  v_cvt_pk_bf16_f32 v79, v94, v95
  buffer_store_dwordx4 v[76:79], v17, s[20:23], s43 offen offset:3072 sc1
  ds_write_b128 v29, v[76:79] offset:12288
  v_pk_mul_f32 v[108:109], v[108:109], v[200:201]
  v_pk_mul_f32 v[110:111], v[110:111], v[200:201]
  v_pk_mul_f32 v[124:125], v[124:125], v[200:201]
  v_pk_mul_f32 v[126:127], v[126:127], v[200:201]
  v_cvt_pk_bf16_f32 v108, v108, v109
  v_cvt_pk_bf16_f32 v109, v110, v111
  v_cvt_pk_bf16_f32 v110, v124, v125
  v_cvt_pk_bf16_f32 v111, v126, v127
  buffer_store_dwordx4 v[108:111], v17, s[20:23], s44 offen offset:3072 sc1
  ds_write_b128 v30, v[108:111] offset:3072
  v_pk_mul_f32 v[140:141], v[140:141], v[200:201]
  v_pk_mul_f32 v[142:143], v[142:143], v[200:201]
  v_pk_mul_f32 v[156:157], v[156:157], v[200:201]
  v_pk_mul_f32 v[158:159], v[158:159], v[200:201]
  v_cvt_pk_bf16_f32 v140, v140, v141
  v_cvt_pk_bf16_f32 v141, v142, v143
  v_cvt_pk_bf16_f32 v142, v156, v157
  v_cvt_pk_bf16_f32 v143, v158, v159
  buffer_store_dwordx4 v[140:143], v17, s[20:23], s45 offen offset:3072 sc1
  ds_write_b128 v30, v[140:143] offset:12288
  s_waitcnt lgkmcnt(0)
  s_barrier
  s_xor_b32 s48, s3, 1
  s_mul_i32 s48, s48, 5120
  s_add_u32 s48, s48, 139264
  v_add_u32 v27, s48, v17
  ds_read_b128 v[216:219], v27 offset:0
  ds_read_b128 v[220:223], v27 offset:1024
  ds_read_b128 v[224:227], v27 offset:2048
  ds_read_b128 v[228:231], v27 offset:3072
  ds_read_b128 v[204:207], v27 offset:4096
  s_waitcnt lgkmcnt(4)
  v_add_f32 v160, v160, v216
  v_add_f32 v161, v161, v217
  v_add_f32 v162, v162, v218
  v_add_f32 v163, v163, v219
  s_waitcnt lgkmcnt(3)
  v_add_f32 v164, v164, v220
  v_add_f32 v165, v165, v221
  v_add_f32 v166, v166, v222
  v_add_f32 v167, v167, v223
  s_waitcnt lgkmcnt(2)
  v_add_f32 v168, v168, v224
  v_add_f32 v169, v169, v225
  v_add_f32 v170, v170, v226
  v_add_f32 v171, v171, v227
  s_waitcnt lgkmcnt(1)
  v_add_f32 v172, v172, v228
  v_add_f32 v173, v173, v229
  v_add_f32 v174, v174, v230
  v_add_f32 v175, v175, v231
  s_waitcnt lgkmcnt(0)
  v_add_f32 v196, v196, v204
  v_cmp_le_f32 vcc, s52, v196
  v_cmp_ge_f32 s[58:59], s53, v196
  v_rcp_f32 v196, v196
  s_nop 1
  s_and_b64 s[56:57], s[56:57], vcc
  s_and_b64 s[56:57], s[56:57], s[58:59]
  s_cmp_eq_u64 s[56:57], exec
  s_cselect_b32 s48, 0, 1
  v_mov_b32 v27, s48
  s_lshl_b32 s48, s3, 2
  s_add_u32 s48, s48, 159744
  v_mov_b32 v28, s48
  ds_write_b32 v28, v27
  v_mov_b32 v201, v196
  v_mov_b32 v200, v196
  v_pk_mul_f32 v[160:161], v[160:161], v[200:201]
  v_pk_mul_f32 v[162:163], v[162:163], v[200:201]
  v_pk_mul_f32 v[164:165], v[164:165], v[200:201]
  v_pk_mul_f32 v[166:167], v[166:167], v[200:201]
  v_cvt_pk_bf16_f32 v160, v160, v161
  v_cvt_pk_bf16_f32 v161, v162, v163
  v_cvt_pk_bf16_f32 v162, v164, v165
  v_cvt_pk_bf16_f32 v163, v166, v167
  buffer_store_dwordx4 v[160:163], v17, s[20:23], s46 offen sc1
  ds_write_b128 v31, v[160:163] offset:8192
  v_pk_mul_f32 v[168:169], v[168:169], v[200:201]
  v_pk_mul_f32 v[170:171], v[170:171], v[200:201]
  v_pk_mul_f32 v[172:173], v[172:173], v[200:201]
  v_pk_mul_f32 v[174:175], v[174:175], v[200:201]
  v_cvt_pk_bf16_f32 v168, v168, v169
  v_cvt_pk_bf16_f32 v169, v170, v171
  v_cvt_pk_bf16_f32 v170, v172, v173
  v_cvt_pk_bf16_f32 v171, v174, v175
  buffer_store_dwordx4 v[168:171], v17, s[20:23], s47 offen sc1
  ds_write_b128 v31, v[168:171] offset:17408
  s_waitcnt vmcnt(0) lgkmcnt(0)
  s_barrier
  v_mov_b32 v28, 159744
  ds_read_b128 v[204:207], v28
  s_waitcnt lgkmcnt(0)
  v_or_b32 v27, v204, v205
  v_or_b32 v28, v206, v207
  v_or_b32 v27, v27, v28
  s_nop 0
  v_readfirstlane_b32 s48, v27
  s_cmp_eq_u32 s51, 0
  s_nop 2
  s_cselect_b32 s48, s48, 0
  s_cmp_eq_u32 s48, 0
  s_cbranch_scc0 concat_heads__gqa_block_cached__mha_block_cached__near_ridge_kernel_fallback
  s_and_b32 s46, s2, 3
  s_bfe_u32 s47, s2, 0x20003
  s_lshl_b32 s52, s27, 2
  s_add_u32 s52, s52, s46
  s_lshl_b32 s52, s52, 3
  s_add_u32 s52, s52, s28
  s_lshl_b32 s52, s52, 7
  s_add_u32 s43, s52, 20971520
  s_lshl_b32 s52, s27, 3
  s_add_u32 s52, s52, s28
  s_lshl_b32 s52, s52, 2
  s_add_u32 s52, s52, s47
  s_mul_i32 s53, s52, 294912
  s_add_u32 s53, s53, 23068672
  s_lshl_b32 s52, s52, 7
  s_add_u32 s44, s52, 20979712
  s_add_u32 s4, s54, s53
  s_addc_u32 s5, s55, 0
  s_mov_b32 s6, 294912
  s_mov_b32 s7, 0x20000
  s_mov_b32 s12, s84
  s_mov_b32 s13, s85
  s_mov_b32 s14, 2359296
  s_mov_b32 s15, 0x20000
  s_mul_i32 s45, s3, 5
  s_cmp_eq_u32 s3, 3
  s_cselect_b32 s53, 1, 0
  s_sub_u32 s45, s45, s53
  s_lshl_b32 s45, s45, 10
  s_cmp_eq_u32 s3, 0
  s_cbranch_scc0 concat_heads__gqa_block_cached__mha_block_cached__near_ridge_kernel_w045
  s_mov_b32 s97, 0
  v_mov_b32 v27, 0
  v_readfirstlane_b32 s88, v240
  v_readfirstlane_b32 s89, v241
  s_nop 3
  s_cmp_lg_u32 s88, 0
  s_cbranch_scc1 concat_heads__gqa_block_cached__mha_block_cached__near_ridge_kernel_nd47
concat_heads__gqa_block_cached__mha_block_cached__near_ridge_kernel_np46:
  global_load_dwordx2 v[30:31], v27, s[86:87] sc1
  s_waitcnt vmcnt(0)
  v_readfirstlane_b32 s88, v30
  v_readfirstlane_b32 s89, v31
  s_nop 3
  s_cmp_lg_u32 s88, 0
  s_cbranch_scc1 concat_heads__gqa_block_cached__mha_block_cached__near_ridge_kernel_nd47
  s_sleep 1
  s_add_u32 s97, s97, 1
  s_cmp_lt_u32 s97, 0x40000
  s_cbranch_scc1 concat_heads__gqa_block_cached__mha_block_cached__near_ridge_kernel_np46
concat_heads__gqa_block_cached__mha_block_cached__near_ridge_kernel_nd47:
  s_lshl_b32 s48, s47, 3
  s_add_u32 s48, s48, s43
  v_mov_b32 v27, s48
  v_mov_b32 v30, s88
  v_mov_b32 v31, s89
  s_mov_b64 exec, 1
  s_nop 4
  global_store_dwordx2 v27, v[30:31], s[54:55] sc1
  s_mov_b64 exec, -1
  s_mov_b64 exec, 15
  s_nop 4
  v_lshlrev_b32 v16, 3, v0
  v_add_u32 v16, s43, v16
  global_load_dwordx2 v[28:29], v16, s[54:55] sc1
  s_mov_b64 exec, -1
concat_heads__gqa_block_cached__mha_block_cached__near_ridge_kernel_w045:
  s_lshl_b32 s38, s3, 12
  s_mul_i32 s33, s46, 294912
  s_cmp_lt_u32 s3, 2
  s_cselect_b64 vcc, -1, 0
  v_mov_b32 v32, 0
  v_mov_b32 v33, 0
  v_mov_b32 v34, 0
  v_mov_b32 v35, 0
  v_mov_b32 v36, 0
  v_mov_b32 v37, 0
  v_mov_b32 v38, 0
  v_mov_b32 v39, 0
  v_mov_b32 v40, 0
  v_mov_b32 v41, 0
  v_mov_b32 v42, 0
  v_mov_b32 v43, 0
  v_mov_b32 v44, 0
  v_mov_b32 v45, 0
  v_mov_b32 v46, 0
  v_mov_b32 v47, 0
  v_mov_b32 v48, 0
  v_mov_b32 v49, 0
  v_mov_b32 v50, 0
  v_mov_b32 v51, 0
  v_mov_b32 v52, 0
  v_mov_b32 v53, 0
  v_mov_b32 v54, 0
  v_mov_b32 v55, 0
  v_mov_b32 v56, 0
  v_mov_b32 v57, 0
  v_mov_b32 v58, 0
  v_mov_b32 v59, 0
  v_mov_b32 v60, 0
  v_mov_b32 v61, 0
  v_mov_b32 v62, 0
  v_mov_b32 v63, 0
  v_mov_b32 v64, 0
  v_mov_b32 v65, 0
  v_mov_b32 v66, 0
  v_mov_b32 v67, 0
  v_mov_b32 v68, 0
  v_mov_b32 v69, 0
  v_mov_b32 v70, 0
  v_mov_b32 v71, 0
  v_mov_b32 v72, 0
  v_mov_b32 v73, 0
  v_mov_b32 v74, 0
  v_mov_b32 v75, 0
  v_mov_b32 v76, 0
  v_mov_b32 v77, 0
  v_mov_b32 v78, 0
  v_mov_b32 v79, 0
  v_mov_b32 v80, 0
  v_mov_b32 v81, 0
  v_mov_b32 v82, 0
  v_mov_b32 v83, 0
  v_mov_b32 v84, 0
  v_mov_b32 v85, 0
  v_mov_b32 v86, 0
  v_mov_b32 v87, 0
  v_mov_b32 v88, 0
  v_mov_b32 v89, 0
  v_mov_b32 v90, 0
  v_mov_b32 v91, 0
  v_mov_b32 v92, 0
  v_mov_b32 v93, 0
  v_mov_b32 v94, 0
  v_mov_b32 v95, 0
  v_mov_b32 v96, 0
  v_mov_b32 v97, 0
  v_mov_b32 v98, 0
  v_mov_b32 v99, 0
  v_mov_b32 v100, 0
  v_mov_b32 v101, 0
  v_mov_b32 v102, 0
  v_mov_b32 v103, 0
  ds_read_b64_tr_b16 a[0:1], v21 offset:0
  ds_read_b64_tr_b16 a[2:3], v21 offset:4096
  ds_read_b64_tr_b16 a[4:5], v21 offset:8
  ds_read_b64_tr_b16 a[6:7], v21 offset:4104
  ds_read_b128 a[16:19], v22 offset:0
  ds_read_b128 a[20:23], v22 offset:1024
  ds_read_b128 a[24:27], v22 offset:2048
  ds_read_b128 a[28:31], v22 offset:3072
  ds_read_b128 a[32:35], v22 offset:4096
  ds_read_b128 a[36:39], v22 offset:5120
  ds_read_b128 a[40:43], v22 offset:6144
  ds_read_b128 a[44:47], v22 offset:7168
  ds_read_b128 a[48:51], v22 offset:8192
  ds_read_b64_tr_b16 a[8:9], v21 offset:8192
  ds_read_b64_tr_b16 a[10:11], v21 offset:12288
  s_waitcnt lgkmcnt(7)
  ds_read_b64_tr_b16 a[12:13], v21 offset:8200
  ds_read_b64_tr_b16 a[14:15], v21 offset:12296
  ds_read_b128 a[52:55], v22 offset:9216
  ds_read_b128 a[56:59], v22 offset:10240
  ds_read_b128 a[60:63], v22 offset:11264
  ds_read_b128 a[64:67], v22 offset:12288
  ds_read_b128 a[68:71], v22 offset:13312
  ds_read_b128 a[72:75], v22 offset:14336
  s_waitcnt lgkmcnt(7)
  ds_read_b128 a[76:79], v22 offset:15360
  ds_read_b128 a[80:83], v22 offset:16384
  ds_read_b128 a[84:87], v22 offset:17408
  s_add_u32 s34, s26, 4
  s_and_b32 s34, s34, 15
  s_mul_i32 s48, s34, 18432
  s_add_u32 s50, s33, s48
  s_lshl_b32 s41, s34, 16
  s_mov_b32 s32, s50
  s_mul_i32 s48, s26, 18432
  s_add_u32 s50, s33, s48
  s_mov_b32 s30, 0
concat_heads__gqa_block_cached__mha_block_cached__near_ridge_kernel_oloop:
  s_cmp_eq_u32 s30, 0
  s_cbranch_scc1 concat_heads__gqa_block_cached__mha_block_cached__near_ridge_kernel_od49
  s_waitcnt vmcnt(16)
concat_heads__gqa_block_cached__mha_block_cached__near_ridge_kernel_od49:
  s_waitcnt lgkmcnt(0)
  s_barrier
  v_mfma_f32_16x16x32_bf16 v[32:35], a[0:3], a[16:19], v[32:35]
  ds_read_b64_tr_b16 a[88:89], v21 offset:16384
  v_mfma_f32_16x16x32_bf16 v[36:39], a[0:3], a[20:23], v[36:39]
  s_add_u32 m0, s45, 65536
  s_add_u32 s37, s50, 0
  buffer_load_dwordx4 v20, s[20:23], s37 offen sc1 lds
  v_mfma_f32_16x16x32_bf16 v[40:43], a[0:3], a[24:27], v[40:43]
  ds_read_b64_tr_b16 a[90:91], v21 offset:20480
  v_mfma_f32_16x16x32_bf16 v[44:47], a[0:3], a[28:31], v[44:47]
  ds_read_b64_tr_b16 a[92:93], v21 offset:16392
  v_mfma_f32_16x16x32_bf16 v[48:51], a[0:3], a[32:35], v[48:51]
  ds_read_b64_tr_b16 a[94:95], v21 offset:20488
  buffer_load_dwordx4 v20, s[20:23], s37 offen offset:1024 sc1 lds
  v_mfma_f32_16x16x32_bf16 v[52:55], a[0:3], a[36:39], v[52:55]
  ds_read_b128 a[104:107], v22 offset:18432
  v_mfma_f32_16x16x32_bf16 v[56:59], a[0:3], a[40:43], v[56:59]
  ds_read_b128 a[108:111], v22 offset:19456
  v_mfma_f32_16x16x32_bf16 v[60:63], a[0:3], a[44:47], v[60:63]
  ds_read_b128 a[112:115], v22 offset:20480
  v_mfma_f32_16x16x32_bf16 v[64:67], a[0:3], a[48:51], v[64:67]
  buffer_load_dwordx4 v20, s[20:23], s37 offen offset:2048 sc1 lds
  v_mfma_f32_16x16x32_bf16 v[68:71], a[4:7], a[16:19], v[68:71]
  ds_read_b128 a[116:119], v22 offset:21504
  ds_read_b128 a[120:123], v22 offset:22528
  v_mfma_f32_16x16x32_bf16 v[72:75], a[4:7], a[20:23], v[72:75]
  ds_read_b128 a[124:127], v22 offset:23552
  v_mfma_f32_16x16x32_bf16 v[76:79], a[4:7], a[24:27], v[76:79]
  buffer_load_dwordx4 v20, s[20:23], s37 offen offset:3072 sc1 lds
  v_mfma_f32_16x16x32_bf16 v[80:83], a[4:7], a[28:31], v[80:83]
  ds_read_b128 a[128:131], v22 offset:24576
  v_mfma_f32_16x16x32_bf16 v[84:87], a[4:7], a[32:35], v[84:87]
  ds_read_b128 a[132:135], v22 offset:25600
  v_mfma_f32_16x16x32_bf16 v[88:91], a[4:7], a[36:39], v[88:91]
  ds_read_b128 a[136:139], v22 offset:26624
  s_cbranch_vccz concat_heads__gqa_block_cached__mha_block_cached__near_ridge_kernel_o550
  s_add_u32 m0, s45, 69632
  s_add_u32 s37, s37, 4096
  buffer_load_dwordx4 v20, s[20:23], s37 offen sc1 lds
concat_heads__gqa_block_cached__mha_block_cached__near_ridge_kernel_o550:
  v_mfma_f32_16x16x32_bf16 v[92:95], a[4:7], a[40:43], v[92:95]
  ds_read_b64_tr_b16 a[96:97], v21 offset:24576
  v_mfma_f32_16x16x32_bf16 v[96:99], a[4:7], a[44:47], v[96:99]
  ds_read_b64_tr_b16 a[98:99], v21 offset:28672
  v_mfma_f32_16x16x32_bf16 v[100:103], a[4:7], a[48:51], v[100:103]
  s_waitcnt lgkmcnt(7)
  ds_read_b64_tr_b16 a[100:101], v21 offset:24584
  v_mfma_f32_16x16x32_bf16 v[32:35], a[8:11], a[52:55], v[32:35]
  s_add_u32 m0, s38, 0
  s_add_u32 s36, s41, 0
  buffer_load_dwordx4 v19, s[8:11], s36 offen  lds
  v_mfma_f32_16x16x32_bf16 v[36:39], a[8:11], a[56:59], v[36:39]
  ds_read_b64_tr_b16 a[102:103], v21 offset:28680
  ds_read_b128 a[140:143], v22 offset:27648
  v_mfma_f32_16x16x32_bf16 v[40:43], a[8:11], a[60:63], v[40:43]
  ds_read_b128 a[144:147], v22 offset:28672
  v_mfma_f32_16x16x32_bf16 v[44:47], a[8:11], a[64:67], v[44:47]
  buffer_load_dwordx4 v23, s[8:11], s36 offen offset:1024  lds
  v_mfma_f32_16x16x32_bf16 v[48:51], a[8:11], a[68:71], v[48:51]
  ds_read_b128 a[148:151], v22 offset:29696
  v_mfma_f32_16x16x32_bf16 v[52:55], a[8:11], a[72:75], v[52:55]
  ds_read_b128 a[152:155], v22 offset:30720
  v_mfma_f32_16x16x32_bf16 v[56:59], a[8:11], a[76:79], v[56:59]
  ds_read_b128 a[156:159], v22 offset:31744
  buffer_load_dwordx4 v24, s[8:11], s36 offen offset:2048  lds
  v_mfma_f32_16x16x32_bf16 v[60:63], a[8:11], a[80:83], v[60:63]
  ds_read_b128 a[160:163], v22 offset:32768
  v_mfma_f32_16x16x32_bf16 v[64:67], a[8:11], a[84:87], v[64:67]
  s_waitcnt lgkmcnt(7)
  ds_read_b128 a[164:167], v22 offset:33792
  v_mfma_f32_16x16x32_bf16 v[68:71], a[12:15], a[52:55], v[68:71]
  ds_read_b128 a[168:171], v22 offset:34816
  v_mfma_f32_16x16x32_bf16 v[72:75], a[12:15], a[56:59], v[72:75]
  buffer_load_dwordx4 v25, s[8:11], s36 offen offset:3072  lds
  ds_read_b128 a[172:175], v22 offset:35840
  v_mfma_f32_16x16x32_bf16 v[76:79], a[12:15], a[60:63], v[76:79]
  v_mfma_f32_16x16x32_bf16 v[80:83], a[12:15], a[64:67], v[80:83]
  v_mfma_f32_16x16x32_bf16 v[84:87], a[12:15], a[68:71], v[84:87]
  v_mfma_f32_16x16x32_bf16 v[88:91], a[12:15], a[72:75], v[88:91]
  v_mfma_f32_16x16x32_bf16 v[92:95], a[12:15], a[76:79], v[92:95]
  v_mfma_f32_16x16x32_bf16 v[96:99], a[12:15], a[80:83], v[96:99]
  v_mfma_f32_16x16x32_bf16 v[100:103], a[12:15], a[84:87], v[100:103]
  s_cmp_eq_u32 s30, 0
  s_cbranch_scc1 concat_heads__gqa_block_cached__mha_block_cached__near_ridge_kernel_od52
  s_waitcnt vmcnt(16)
concat_heads__gqa_block_cached__mha_block_cached__near_ridge_kernel_od52:
  s_cmp_eq_u32 s30, 0
  s_cbranch_scc0 concat_heads__gqa_block_cached__mha_block_cached__near_ridge_kernel_op53
  s_cmp_eq_u32 s3, 0
  s_cbranch_scc0 concat_heads__gqa_block_cached__mha_block_cached__near_ridge_kernel_op53
  s_waitcnt vmcnt(9)
  s_mov_b64 exec, 15
  s_nop 4
  v_cmp_eq_u32 vcc, s88, v28
  v_cmp_eq_u32 s[56:57], s89, v29
  s_lshl_b32 s48, 1, s47
  s_nop 3
  s_and_b64 s[56:57], s[56:57], vcc
  s_or_b32 s56, s56, s48
  s_cmp_eq_u64 s[56:57], exec
  s_mov_b64 exec, -1
  s_cbranch_scc1 concat_heads__gqa_block_cached__mha_block_cached__near_ridge_kernel_oq54
  s_mov_b64 exec, 15
  s_nop 4
  v_lshlrev_b32 v27, 3, v0
  v_add_u32 v27, s43, v27
  s_mov_b32 s97, 0
concat_heads__gqa_block_cached__mha_block_cached__near_ridge_kernel_f1p55:
  global_load_dwordx2 v[30:31], v27, s[54:55] sc1
  s_waitcnt vmcnt(0)
  v_cmp_eq_u32 vcc, s88, v30
  v_cmp_eq_u32 s[56:57], s89, v31
  s_nop 3
  s_and_b64 s[56:57], s[56:57], vcc
  s_cmp_eq_u64 s[56:57], exec
  s_cbranch_scc1 concat_heads__gqa_block_cached__mha_block_cached__near_ridge_kernel_f1d56
  s_sleep 1
  s_add_u32 s97, s97, 1
  s_cmp_lt_u32 s97, 0x40000
  s_cbranch_scc1 concat_heads__gqa_block_cached__mha_block_cached__near_ridge_kernel_f1p55
concat_heads__gqa_block_cached__mha_block_cached__near_ridge_kernel_f1d56:
  s_mov_b64 exec, -1
concat_heads__gqa_block_cached__mha_block_cached__near_ridge_kernel_oq54:
  s_cmp_lt_u32 s3, 2
  s_cselect_b64 vcc, -1, 0
concat_heads__gqa_block_cached__mha_block_cached__near_ridge_kernel_op53:
  s_waitcnt lgkmcnt(0)
  s_barrier
  s_cmp_eq_u32 s30, 0
  s_cbranch_scc0 concat_heads__gqa_block_cached__mha_block_cached__near_ridge_kernel_ox57
  s_mov_b32 s50, s32
  s_add_u32 m0, s45, 65536
  s_add_u32 s37, s50, 0
  buffer_load_dwordx4 v20, s[20:23], s37 offen sc1 lds
  buffer_load_dwordx4 v20, s[20:23], s37 offen offset:1024 sc1 lds
  buffer_load_dwordx4 v20, s[20:23], s37 offen offset:2048 sc1 lds
  buffer_load_dwordx4 v20, s[20:23], s37 offen offset:3072 sc1 lds
  s_cbranch_vccz concat_heads__gqa_block_cached__mha_block_cached__near_ridge_kernel_o558
  s_add_u32 m0, s45, 69632
  s_add_u32 s37, s37, 4096
  buffer_load_dwordx4 v20, s[20:23], s37 offen sc1 lds
concat_heads__gqa_block_cached__mha_block_cached__near_ridge_kernel_o558:
concat_heads__gqa_block_cached__mha_block_cached__near_ridge_kernel_ox57:
  v_mfma_f32_16x16x32_bf16 v[32:35], a[88:91], a[104:107], v[32:35]
  ds_read_b64_tr_b16 a[0:1], v21 offset:32768
  v_mfma_f32_16x16x32_bf16 v[36:39], a[88:91], a[108:111], v[36:39]
  s_add_u32 m0, s45, 83968
  s_add_u32 s37, s50, 18432
  buffer_load_dwordx4 v20, s[20:23], s37 offen sc1 lds
  v_mfma_f32_16x16x32_bf16 v[40:43], a[88:91], a[112:115], v[40:43]
  ds_read_b64_tr_b16 a[2:3], v21 offset:36864
  v_mfma_f32_16x16x32_bf16 v[44:47], a[88:91], a[116:119], v[44:47]
  ds_read_b64_tr_b16 a[4:5], v21 offset:32776
  v_mfma_f32_16x16x32_bf16 v[48:51], a[88:91], a[120:123], v[48:51]
  ds_read_b64_tr_b16 a[6:7], v21 offset:36872
  buffer_load_dwordx4 v20, s[20:23], s37 offen offset:1024 sc1 lds
  v_mfma_f32_16x16x32_bf16 v[52:55], a[88:91], a[124:127], v[52:55]
  ds_read_b128 a[16:19], v26 offset:0
  v_mfma_f32_16x16x32_bf16 v[56:59], a[88:91], a[128:131], v[56:59]
  ds_read_b128 a[20:23], v26 offset:1024
  v_mfma_f32_16x16x32_bf16 v[60:63], a[88:91], a[132:135], v[60:63]
  ds_read_b128 a[24:27], v26 offset:2048
  v_mfma_f32_16x16x32_bf16 v[64:67], a[88:91], a[136:139], v[64:67]
  buffer_load_dwordx4 v20, s[20:23], s37 offen offset:2048 sc1 lds
  v_mfma_f32_16x16x32_bf16 v[68:71], a[92:95], a[104:107], v[68:71]
  ds_read_b128 a[28:31], v26 offset:3072
  ds_read_b128 a[32:35], v26 offset:4096
  v_mfma_f32_16x16x32_bf16 v[72:75], a[92:95], a[108:111], v[72:75]
  ds_read_b128 a[36:39], v26 offset:5120
  v_mfma_f32_16x16x32_bf16 v[76:79], a[92:95], a[112:115], v[76:79]
  buffer_load_dwordx4 v20, s[20:23], s37 offen offset:3072 sc1 lds
  v_mfma_f32_16x16x32_bf16 v[80:83], a[92:95], a[116:119], v[80:83]
  ds_read_b128 a[40:43], v26 offset:6144
  v_mfma_f32_16x16x32_bf16 v[84:87], a[92:95], a[120:123], v[84:87]
  ds_read_b128 a[44:47], v26 offset:7168
  v_mfma_f32_16x16x32_bf16 v[88:91], a[92:95], a[124:127], v[88:91]
  ds_read_b128 a[48:51], v26 offset:8192
  s_cbranch_vccz concat_heads__gqa_block_cached__mha_block_cached__near_ridge_kernel_o559
  s_add_u32 m0, s45, 88064
  s_add_u32 s37, s37, 4096
  buffer_load_dwordx4 v20, s[20:23], s37 offen sc1 lds
concat_heads__gqa_block_cached__mha_block_cached__near_ridge_kernel_o559:
  v_mfma_f32_16x16x32_bf16 v[92:95], a[92:95], a[128:131], v[92:95]
  ds_read_b64_tr_b16 a[8:9], v21 offset:40960
  v_mfma_f32_16x16x32_bf16 v[96:99], a[92:95], a[132:135], v[96:99]
  ds_read_b64_tr_b16 a[10:11], v21 offset:45056
  v_mfma_f32_16x16x32_bf16 v[100:103], a[92:95], a[136:139], v[100:103]
  s_waitcnt lgkmcnt(7)
  ds_read_b64_tr_b16 a[12:13], v21 offset:40968
  v_mfma_f32_16x16x32_bf16 v[32:35], a[96:99], a[140:143], v[32:35]
  s_add_u32 m0, s38, 16384
  s_add_u32 s36, s41, 65536
  buffer_load_dwordx4 v19, s[8:11], s36 offen  lds
  v_mfma_f32_16x16x32_bf16 v[36:39], a[96:99], a[144:147], v[36:39]
  ds_read_b64_tr_b16 a[14:15], v21 offset:45064
  ds_read_b128 a[52:55], v26 offset:9216
  v_mfma_f32_16x16x32_bf16 v[40:43], a[96:99], a[148:151], v[40:43]
  ds_read_b128 a[56:59], v26 offset:10240
  v_mfma_f32_16x16x32_bf16 v[44:47], a[96:99], a[152:155], v[44:47]
  buffer_load_dwordx4 v23, s[8:11], s36 offen offset:1024  lds
  v_mfma_f32_16x16x32_bf16 v[48:51], a[96:99], a[156:159], v[48:51]
  ds_read_b128 a[60:63], v26 offset:11264
  v_mfma_f32_16x16x32_bf16 v[52:55], a[96:99], a[160:163], v[52:55]
  ds_read_b128 a[64:67], v26 offset:12288
  v_mfma_f32_16x16x32_bf16 v[56:59], a[96:99], a[164:167], v[56:59]
  ds_read_b128 a[68:71], v26 offset:13312
  buffer_load_dwordx4 v24, s[8:11], s36 offen offset:2048  lds
  v_mfma_f32_16x16x32_bf16 v[60:63], a[96:99], a[168:171], v[60:63]
  ds_read_b128 a[72:75], v26 offset:14336
  v_mfma_f32_16x16x32_bf16 v[64:67], a[96:99], a[172:175], v[64:67]
  s_waitcnt lgkmcnt(7)
  ds_read_b128 a[76:79], v26 offset:15360
  v_mfma_f32_16x16x32_bf16 v[68:71], a[100:103], a[140:143], v[68:71]
  ds_read_b128 a[80:83], v26 offset:16384
  v_mfma_f32_16x16x32_bf16 v[72:75], a[100:103], a[144:147], v[72:75]
  buffer_load_dwordx4 v25, s[8:11], s36 offen offset:3072  lds
  ds_read_b128 a[84:87], v26 offset:17408
  v_mfma_f32_16x16x32_bf16 v[76:79], a[100:103], a[148:151], v[76:79]
  v_mfma_f32_16x16x32_bf16 v[80:83], a[100:103], a[152:155], v[80:83]
  v_mfma_f32_16x16x32_bf16 v[84:87], a[100:103], a[156:159], v[84:87]
  v_mfma_f32_16x16x32_bf16 v[88:91], a[100:103], a[160:163], v[88:91]
  v_mfma_f32_16x16x32_bf16 v[92:95], a[100:103], a[164:167], v[92:95]
  v_mfma_f32_16x16x32_bf16 v[96:99], a[100:103], a[168:171], v[96:99]
  v_mfma_f32_16x16x32_bf16 v[100:103], a[100:103], a[172:175], v[100:103]
  s_cmp_eq_u32 s30, 0
  s_cbranch_scc1 concat_heads__gqa_block_cached__mha_block_cached__near_ridge_kernel_od61
  s_waitcnt vmcnt(16)
concat_heads__gqa_block_cached__mha_block_cached__near_ridge_kernel_od61:
  s_waitcnt lgkmcnt(0)
  s_barrier
  v_mfma_f32_16x16x32_bf16 v[32:35], a[0:3], a[16:19], v[32:35]
  ds_read_b64_tr_b16 a[88:89], v21 offset:49152
  v_mfma_f32_16x16x32_bf16 v[36:39], a[0:3], a[20:23], v[36:39]
  s_add_u32 m0, s45, 102400
  s_add_u32 s37, s50, 36864
  buffer_load_dwordx4 v20, s[20:23], s37 offen sc1 lds
  v_mfma_f32_16x16x32_bf16 v[40:43], a[0:3], a[24:27], v[40:43]
  ds_read_b64_tr_b16 a[90:91], v21 offset:53248
  v_mfma_f32_16x16x32_bf16 v[44:47], a[0:3], a[28:31], v[44:47]
  ds_read_b64_tr_b16 a[92:93], v21 offset:49160
  v_mfma_f32_16x16x32_bf16 v[48:51], a[0:3], a[32:35], v[48:51]
  ds_read_b64_tr_b16 a[94:95], v21 offset:53256
  buffer_load_dwordx4 v20, s[20:23], s37 offen offset:1024 sc1 lds
  v_mfma_f32_16x16x32_bf16 v[52:55], a[0:3], a[36:39], v[52:55]
  ds_read_b128 a[104:107], v26 offset:18432
  v_mfma_f32_16x16x32_bf16 v[56:59], a[0:3], a[40:43], v[56:59]
  ds_read_b128 a[108:111], v26 offset:19456
  v_mfma_f32_16x16x32_bf16 v[60:63], a[0:3], a[44:47], v[60:63]
  ds_read_b128 a[112:115], v26 offset:20480
  v_mfma_f32_16x16x32_bf16 v[64:67], a[0:3], a[48:51], v[64:67]
  buffer_load_dwordx4 v20, s[20:23], s37 offen offset:2048 sc1 lds
  v_mfma_f32_16x16x32_bf16 v[68:71], a[4:7], a[16:19], v[68:71]
  ds_read_b128 a[116:119], v26 offset:21504
  ds_read_b128 a[120:123], v26 offset:22528
  v_mfma_f32_16x16x32_bf16 v[72:75], a[4:7], a[20:23], v[72:75]
  ds_read_b128 a[124:127], v26 offset:23552
  v_mfma_f32_16x16x32_bf16 v[76:79], a[4:7], a[24:27], v[76:79]
  buffer_load_dwordx4 v20, s[20:23], s37 offen offset:3072 sc1 lds
  v_mfma_f32_16x16x32_bf16 v[80:83], a[4:7], a[28:31], v[80:83]
  ds_read_b128 a[128:131], v26 offset:24576
  v_mfma_f32_16x16x32_bf16 v[84:87], a[4:7], a[32:35], v[84:87]
  ds_read_b128 a[132:135], v26 offset:25600
  v_mfma_f32_16x16x32_bf16 v[88:91], a[4:7], a[36:39], v[88:91]
  ds_read_b128 a[136:139], v26 offset:26624
  s_cbranch_vccz concat_heads__gqa_block_cached__mha_block_cached__near_ridge_kernel_o562
  s_add_u32 m0, s45, 106496
  s_add_u32 s37, s37, 4096
  buffer_load_dwordx4 v20, s[20:23], s37 offen sc1 lds
concat_heads__gqa_block_cached__mha_block_cached__near_ridge_kernel_o562:
  v_mfma_f32_16x16x32_bf16 v[92:95], a[4:7], a[40:43], v[92:95]
  ds_read_b64_tr_b16 a[96:97], v21 offset:57344
  v_mfma_f32_16x16x32_bf16 v[96:99], a[4:7], a[44:47], v[96:99]
  ds_read_b64_tr_b16 a[98:99], v21 offset:61440
  v_mfma_f32_16x16x32_bf16 v[100:103], a[4:7], a[48:51], v[100:103]
  s_waitcnt lgkmcnt(7)
  ds_read_b64_tr_b16 a[100:101], v21 offset:57352
  v_mfma_f32_16x16x32_bf16 v[32:35], a[8:11], a[52:55], v[32:35]
  s_add_u32 m0, s38, 32768
  s_add_u32 s36, s41, 131072
  buffer_load_dwordx4 v19, s[8:11], s36 offen  lds
  v_mfma_f32_16x16x32_bf16 v[36:39], a[8:11], a[56:59], v[36:39]
  ds_read_b64_tr_b16 a[102:103], v21 offset:61448
  ds_read_b128 a[140:143], v26 offset:27648
  v_mfma_f32_16x16x32_bf16 v[40:43], a[8:11], a[60:63], v[40:43]
  ds_read_b128 a[144:147], v26 offset:28672
  v_mfma_f32_16x16x32_bf16 v[44:47], a[8:11], a[64:67], v[44:47]
  buffer_load_dwordx4 v23, s[8:11], s36 offen offset:1024  lds
  v_mfma_f32_16x16x32_bf16 v[48:51], a[8:11], a[68:71], v[48:51]
  ds_read_b128 a[148:151], v26 offset:29696
  v_mfma_f32_16x16x32_bf16 v[52:55], a[8:11], a[72:75], v[52:55]
  ds_read_b128 a[152:155], v26 offset:30720
  v_mfma_f32_16x16x32_bf16 v[56:59], a[8:11], a[76:79], v[56:59]
  ds_read_b128 a[156:159], v26 offset:31744
  buffer_load_dwordx4 v24, s[8:11], s36 offen offset:2048  lds
  v_mfma_f32_16x16x32_bf16 v[60:63], a[8:11], a[80:83], v[60:63]
  ds_read_b128 a[160:163], v26 offset:32768
  v_mfma_f32_16x16x32_bf16 v[64:67], a[8:11], a[84:87], v[64:67]
  s_waitcnt lgkmcnt(7)
  ds_read_b128 a[164:167], v26 offset:33792
  v_mfma_f32_16x16x32_bf16 v[68:71], a[12:15], a[52:55], v[68:71]
  ds_read_b128 a[168:171], v26 offset:34816
  v_mfma_f32_16x16x32_bf16 v[72:75], a[12:15], a[56:59], v[72:75]
  buffer_load_dwordx4 v25, s[8:11], s36 offen offset:3072  lds
  ds_read_b128 a[172:175], v26 offset:35840
  v_mfma_f32_16x16x32_bf16 v[76:79], a[12:15], a[60:63], v[76:79]
  v_mfma_f32_16x16x32_bf16 v[80:83], a[12:15], a[64:67], v[80:83]
  v_mfma_f32_16x16x32_bf16 v[84:87], a[12:15], a[68:71], v[84:87]
  v_mfma_f32_16x16x32_bf16 v[88:91], a[12:15], a[72:75], v[88:91]
  v_mfma_f32_16x16x32_bf16 v[92:95], a[12:15], a[76:79], v[92:95]
  v_mfma_f32_16x16x32_bf16 v[96:99], a[12:15], a[80:83], v[96:99]
  v_mfma_f32_16x16x32_bf16 v[100:103], a[12:15], a[84:87], v[100:103]
  s_waitcnt vmcnt(16)
  s_waitcnt lgkmcnt(0)
  s_barrier
  v_mfma_f32_16x16x32_bf16 v[32:35], a[88:91], a[104:107], v[32:35]
  ds_read_b64_tr_b16 a[0:1], v21 offset:0
  v_mfma_f32_16x16x32_bf16 v[36:39], a[88:91], a[108:111], v[36:39]
  s_add_u32 m0, s45, 120832
  s_add_u32 s37, s50, 55296
  buffer_load_dwordx4 v20, s[20:23], s37 offen sc1 lds
  v_mfma_f32_16x16x32_bf16 v[40:43], a[88:91], a[112:115], v[40:43]
  ds_read_b64_tr_b16 a[2:3], v21 offset:4096
  v_mfma_f32_16x16x32_bf16 v[44:47], a[88:91], a[116:119], v[44:47]
  ds_read_b64_tr_b16 a[4:5], v21 offset:8
  v_mfma_f32_16x16x32_bf16 v[48:51], a[88:91], a[120:123], v[48:51]
  ds_read_b64_tr_b16 a[6:7], v21 offset:4104
  buffer_load_dwordx4 v20, s[20:23], s37 offen offset:1024 sc1 lds
  v_mfma_f32_16x16x32_bf16 v[52:55], a[88:91], a[124:127], v[52:55]
  ds_read_b128 a[16:19], v22 offset:0
  v_mfma_f32_16x16x32_bf16 v[56:59], a[88:91], a[128:131], v[56:59]
  ds_read_b128 a[20:23], v22 offset:1024
  v_mfma_f32_16x16x32_bf16 v[60:63], a[88:91], a[132:135], v[60:63]
  ds_read_b128 a[24:27], v22 offset:2048
  v_mfma_f32_16x16x32_bf16 v[64:67], a[88:91], a[136:139], v[64:67]
  buffer_load_dwordx4 v20, s[20:23], s37 offen offset:2048 sc1 lds
  v_mfma_f32_16x16x32_bf16 v[68:71], a[92:95], a[104:107], v[68:71]
  ds_read_b128 a[28:31], v22 offset:3072
  ds_read_b128 a[32:35], v22 offset:4096
  v_mfma_f32_16x16x32_bf16 v[72:75], a[92:95], a[108:111], v[72:75]
  ds_read_b128 a[36:39], v22 offset:5120
  v_mfma_f32_16x16x32_bf16 v[76:79], a[92:95], a[112:115], v[76:79]
  buffer_load_dwordx4 v20, s[20:23], s37 offen offset:3072 sc1 lds
  v_mfma_f32_16x16x32_bf16 v[80:83], a[92:95], a[116:119], v[80:83]
  ds_read_b128 a[40:43], v22 offset:6144
  v_mfma_f32_16x16x32_bf16 v[84:87], a[92:95], a[120:123], v[84:87]
  ds_read_b128 a[44:47], v22 offset:7168
  v_mfma_f32_16x16x32_bf16 v[88:91], a[92:95], a[124:127], v[88:91]
  ds_read_b128 a[48:51], v22 offset:8192
  s_cbranch_vccz concat_heads__gqa_block_cached__mha_block_cached__near_ridge_kernel_o563
  s_add_u32 m0, s45, 124928
  s_add_u32 s37, s37, 4096
  buffer_load_dwordx4 v20, s[20:23], s37 offen sc1 lds
concat_heads__gqa_block_cached__mha_block_cached__near_ridge_kernel_o563:
  v_mfma_f32_16x16x32_bf16 v[92:95], a[92:95], a[128:131], v[92:95]
  ds_read_b64_tr_b16 a[8:9], v21 offset:8192
  v_mfma_f32_16x16x32_bf16 v[96:99], a[92:95], a[132:135], v[96:99]
  ds_read_b64_tr_b16 a[10:11], v21 offset:12288
  v_mfma_f32_16x16x32_bf16 v[100:103], a[92:95], a[136:139], v[100:103]
  s_waitcnt lgkmcnt(7)
  ds_read_b64_tr_b16 a[12:13], v21 offset:8200
  v_mfma_f32_16x16x32_bf16 v[32:35], a[96:99], a[140:143], v[32:35]
  s_add_u32 m0, s38, 49152
  s_add_u32 s36, s41, 196608
  buffer_load_dwordx4 v19, s[8:11], s36 offen  lds
  v_mfma_f32_16x16x32_bf16 v[36:39], a[96:99], a[144:147], v[36:39]
  ds_read_b64_tr_b16 a[14:15], v21 offset:12296
  ds_read_b128 a[52:55], v22 offset:9216
  v_mfma_f32_16x16x32_bf16 v[40:43], a[96:99], a[148:151], v[40:43]
  ds_read_b128 a[56:59], v22 offset:10240
  v_mfma_f32_16x16x32_bf16 v[44:47], a[96:99], a[152:155], v[44:47]
  buffer_load_dwordx4 v23, s[8:11], s36 offen offset:1024  lds
  v_mfma_f32_16x16x32_bf16 v[48:51], a[96:99], a[156:159], v[48:51]
  ds_read_b128 a[60:63], v22 offset:11264
  v_mfma_f32_16x16x32_bf16 v[52:55], a[96:99], a[160:163], v[52:55]
  ds_read_b128 a[64:67], v22 offset:12288
  v_mfma_f32_16x16x32_bf16 v[56:59], a[96:99], a[164:167], v[56:59]
  ds_read_b128 a[68:71], v22 offset:13312
  buffer_load_dwordx4 v24, s[8:11], s36 offen offset:2048  lds
  v_mfma_f32_16x16x32_bf16 v[60:63], a[96:99], a[168:171], v[60:63]
  ds_read_b128 a[72:75], v22 offset:14336
  v_mfma_f32_16x16x32_bf16 v[64:67], a[96:99], a[172:175], v[64:67]
  s_waitcnt lgkmcnt(7)
  ds_read_b128 a[76:79], v22 offset:15360
  v_mfma_f32_16x16x32_bf16 v[68:71], a[100:103], a[140:143], v[68:71]
  ds_read_b128 a[80:83], v22 offset:16384
  v_mfma_f32_16x16x32_bf16 v[72:75], a[100:103], a[144:147], v[72:75]
  buffer_load_dwordx4 v25, s[8:11], s36 offen offset:3072  lds
  ds_read_b128 a[84:87], v22 offset:17408
  v_mfma_f32_16x16x32_bf16 v[76:79], a[100:103], a[148:151], v[76:79]
  v_mfma_f32_16x16x32_bf16 v[80:83], a[100:103], a[152:155], v[80:83]
  v_mfma_f32_16x16x32_bf16 v[84:87], a[100:103], a[156:159], v[84:87]
  v_mfma_f32_16x16x32_bf16 v[88:91], a[100:103], a[160:163], v[88:91]
  v_mfma_f32_16x16x32_bf16 v[92:95], a[100:103], a[164:167], v[92:95]
  v_mfma_f32_16x16x32_bf16 v[96:99], a[100:103], a[168:171], v[96:99]
  v_mfma_f32_16x16x32_bf16 v[100:103], a[100:103], a[172:175], v[100:103]
  s_add_u32 s34, s34, 4
  s_and_b32 s34, s34, 15
  s_mul_i32 s48, s34, 18432
  s_add_u32 s50, s33, s48
  s_lshl_b32 s41, s34, 16
  s_cmp_eq_u32 s30, 2
  s_cselect_b32 s50, 0x7f000000, s50
  s_cselect_b32 s41, 0x7f000000, s41
  s_add_u32 s30, s30, 1
  s_cmp_lt_u32 s30, 4
  s_cbranch_scc1 concat_heads__gqa_block_cached__mha_block_cached__near_ridge_kernel_oloop
  s_waitcnt lgkmcnt(0)
  v_lshlrev_b32 v27, 4, v0
  s_lshl_b32 s52, s3, 11
  v_add_u32 v26, s52, v27
  v_and_b32 v25, 15, v0
  v_lshlrev_b32 v25, 11, v25
  v_lshrrev_b32 v24, 4, v0
  v_lshl_add_u32 v25, v24, 4, v25
  s_lshl_b32 s52, s3, 6
  v_add_u32 v25, s52, v25
  s_mul_i32 s52, s28, 294912
  s_lshl_b32 s53, s27, 10
  s_add_u32 s52, s52, s53
  s_lshl_b32 s53, s47, 8
  s_add_u32 s45, s52, s53
  s_mul_i32 s42, s46, 73728
  s_cmp_eq_u32 s46, 1
  s_cbranch_scc1 concat_heads__gqa_block_cached__mha_block_cached__near_ridge_kernel_oc165
  s_cmp_eq_u32 s46, 2
  s_cbranch_scc1 concat_heads__gqa_block_cached__mha_block_cached__near_ridge_kernel_oc266
  s_cmp_eq_u32 s46, 3
  s_cbranch_scc1 concat_heads__gqa_block_cached__mha_block_cached__near_ridge_kernel_oc367
concat_heads__gqa_block_cached__mha_block_cached__near_ridge_kernel_oc064:
  s_cmp_eq_u32 s3, 0
  s_cbranch_scc0 concat_heads__gqa_block_cached__mha_block_cached__near_ridge_kernel_pe69
  s_mov_b64 exec, 15
  s_nop 4
  v_lshlrev_b32 v16, 3, v0
  v_add_u32 v16, s44, v16
  global_load_dwordx2 v[104:105], v16, s[54:55] sc1
  s_mov_b64 exec, -1
concat_heads__gqa_block_cached__mha_block_cached__near_ridge_kernel_pe69:
  v_cvt_pk_bf16_f32 v44, v44, v45
  v_cvt_pk_bf16_f32 v45, v46, v47
  v_cvt_pk_bf16_f32 v46, v80, v81
  v_cvt_pk_bf16_f32 v47, v82, v83
  s_add_u32 s48, s42, 24576
  buffer_store_dwordx4 v[44:47], v26, s[4:7], s48 offen sc1
  v_cvt_pk_bf16_f32 v48, v48, v49
  v_cvt_pk_bf16_f32 v49, v50, v51
  v_cvt_pk_bf16_f32 v50, v84, v85
  v_cvt_pk_bf16_f32 v51, v86, v87
  s_add_u32 s48, s42, 32768
  buffer_store_dwordx4 v[48:51], v26, s[4:7], s48 offen sc1
  v_cvt_pk_bf16_f32 v52, v52, v53
  v_cvt_pk_bf16_f32 v53, v54, v55
  v_cvt_pk_bf16_f32 v54, v88, v89
  v_cvt_pk_bf16_f32 v55, v90, v91
  s_add_u32 s48, s42, 40960
  buffer_store_dwordx4 v[52:55], v26, s[4:7], s48 offen sc1
  v_cvt_pk_bf16_f32 v56, v56, v57
  v_cvt_pk_bf16_f32 v57, v58, v59
  v_cvt_pk_bf16_f32 v58, v92, v93
  v_cvt_pk_bf16_f32 v59, v94, v95
  s_add_u32 s48, s42, 49152
  buffer_store_dwordx4 v[56:59], v26, s[4:7], s48 offen sc1
  v_cvt_pk_bf16_f32 v60, v60, v61
  v_cvt_pk_bf16_f32 v61, v62, v63
  v_cvt_pk_bf16_f32 v62, v96, v97
  v_cvt_pk_bf16_f32 v63, v98, v99
  s_add_u32 s48, s42, 57344
  buffer_store_dwordx4 v[60:63], v26, s[4:7], s48 offen sc1
  v_cvt_pk_bf16_f32 v64, v64, v65
  v_cvt_pk_bf16_f32 v65, v66, v67
  v_cvt_pk_bf16_f32 v66, v100, v101
  v_cvt_pk_bf16_f32 v67, v102, v103
  s_add_u32 s48, s42, 65536
  buffer_store_dwordx4 v[64:67], v26, s[4:7], s48 offen sc1
  s_waitcnt vmcnt(0)
  s_barrier
  s_cmp_eq_u32 s3, 0
  s_cbranch_scc0 concat_heads__gqa_block_cached__mha_block_cached__near_ridge_kernel_w170
  s_lshl_b32 s48, s46, 3
  s_add_u32 s48, s48, s44
  v_mov_b32 v27, s48
  v_mov_b32 v30, s88
  v_mov_b32 v31, s89
  s_mov_b64 exec, 1
  s_nop 4
  global_store_dwordx2 v27, v[30:31], s[54:55] sc1
  s_mov_b64 exec, -1
  s_mov_b64 exec, 15
  s_nop 4
  v_cmp_eq_u32 vcc, s88, v104
  v_cmp_eq_u32 s[56:57], s89, v105
  s_lshl_b32 s48, 1, s46
  s_nop 3
  s_and_b64 s[56:57], s[56:57], vcc
  s_or_b32 s56, s56, s48
  s_cmp_eq_u64 s[56:57], exec
  s_mov_b64 exec, -1
  s_cbranch_scc1 concat_heads__gqa_block_cached__mha_block_cached__near_ridge_kernel_pq71
  s_mov_b64 exec, 15
  s_nop 4
  v_lshlrev_b32 v27, 3, v0
  v_add_u32 v27, s44, v27
  s_mov_b32 s97, 0
concat_heads__gqa_block_cached__mha_block_cached__near_ridge_kernel_f2p72:
  global_load_dwordx2 v[30:31], v27, s[54:55] sc1
  s_waitcnt vmcnt(0)
  v_cmp_eq_u32 vcc, s88, v30
  v_cmp_eq_u32 s[56:57], s89, v31
  s_nop 3
  s_and_b64 s[56:57], s[56:57], vcc
  s_cmp_eq_u64 s[56:57], exec
  s_cbranch_scc1 concat_heads__gqa_block_cached__mha_block_cached__near_ridge_kernel_f2d73
  s_sleep 1
  s_add_u32 s97, s97, 1
  s_cmp_lt_u32 s97, 0x40000
  s_cbranch_scc1 concat_heads__gqa_block_cached__mha_block_cached__near_ridge_kernel_f2p72
concat_heads__gqa_block_cached__mha_block_cached__near_ridge_kernel_f2d73:
  s_mov_b64 exec, -1
concat_heads__gqa_block_cached__mha_block_cached__near_ridge_kernel_pq71:
concat_heads__gqa_block_cached__mha_block_cached__near_ridge_kernel_w170:
  s_barrier
  s_mov_b32 s48, 73728
  buffer_load_dwordx4 v[112:115], v26, s[4:7], s48 offen offset:0 sc1
  s_mov_b32 s48, 81920
  buffer_load_dwordx4 v[116:119], v26, s[4:7], s48 offen offset:0 sc1
  s_mov_b32 s48, 90112
  buffer_load_dwordx4 v[120:123], v26, s[4:7], s48 offen offset:0 sc1
  s_mov_b32 s48, 147456
  buffer_load_dwordx4 v[124:127], v26, s[4:7], s48 offen offset:0 sc1
  s_mov_b32 s48, 155648
  buffer_load_dwordx4 v[128:131], v26, s[4:7], s48 offen offset:0 sc1
  s_mov_b32 s48, 163840
  buffer_load_dwordx4 v[132:135], v26, s[4:7], s48 offen offset:0 sc1
  s_mov_b32 s48, 221184
  buffer_load_dwordx4 v[136:139], v26, s[4:7], s48 offen offset:0 sc1
  s_mov_b32 s48, 229376
  buffer_load_dwordx4 v[140:143], v26, s[4:7], s48 offen offset:0 sc1
  s_mov_b32 s48, 237568
  buffer_load_dwordx4 v[144:147], v26, s[4:7], s48 offen offset:0 sc1
  s_waitcnt vmcnt(8)
  v_lshlrev_b32 v106, 16, v112
  v_and_b32 v107, 0xffff0000, v112
  v_add_f32 v32, v32, v106
  v_add_f32 v33, v33, v107
  v_lshlrev_b32 v106, 16, v113
  v_and_b32 v107, 0xffff0000, v113
  v_add_f32 v34, v34, v106
  v_add_f32 v35, v35, v107
  v_lshlrev_b32 v106, 16, v114
  v_and_b32 v107, 0xffff0000, v114
  v_add_f32 v68, v68, v106
  v_add_f32 v69, v69, v107
  v_lshlrev_b32 v106, 16, v115
  v_and_b32 v107, 0xffff0000, v115
  v_add_f32 v70, v70, v106
  v_add_f32 v71, v71, v107
  s_waitcnt vmcnt(7)
  v_lshlrev_b32 v106, 16, v116
  v_and_b32 v107, 0xffff0000, v116
  v_add_f32 v36, v36, v106
  v_add_f32 v37, v37, v107
  v_lshlrev_b32 v106, 16, v117
  v_and_b32 v107, 0xffff0000, v117
  v_add_f32 v38, v38, v106
  v_add_f32 v39, v39, v107
  v_lshlrev_b32 v106, 16, v118
  v_and_b32 v107, 0xffff0000, v118
  v_add_f32 v72, v72, v106
  v_add_f32 v73, v73, v107
  v_lshlrev_b32 v106, 16, v119
  v_and_b32 v107, 0xffff0000, v119
  v_add_f32 v74, v74, v106
  v_add_f32 v75, v75, v107
  s_waitcnt vmcnt(6)
  v_lshlrev_b32 v106, 16, v120
  v_and_b32 v107, 0xffff0000, v120
  v_add_f32 v40, v40, v106
  v_add_f32 v41, v41, v107
  v_lshlrev_b32 v106, 16, v121
  v_and_b32 v107, 0xffff0000, v121
  v_add_f32 v42, v42, v106
  v_add_f32 v43, v43, v107
  v_lshlrev_b32 v106, 16, v122
  v_and_b32 v107, 0xffff0000, v122
  v_add_f32 v76, v76, v106
  v_add_f32 v77, v77, v107
  v_lshlrev_b32 v106, 16, v123
  v_and_b32 v107, 0xffff0000, v123
  v_add_f32 v78, v78, v106
  v_add_f32 v79, v79, v107
  s_waitcnt vmcnt(5)
  v_lshlrev_b32 v106, 16, v124
  v_and_b32 v107, 0xffff0000, v124
  v_add_f32 v32, v32, v106
  v_add_f32 v33, v33, v107
  v_lshlrev_b32 v106, 16, v125
  v_and_b32 v107, 0xffff0000, v125
  v_add_f32 v34, v34, v106
  v_add_f32 v35, v35, v107
  v_lshlrev_b32 v106, 16, v126
  v_and_b32 v107, 0xffff0000, v126
  v_add_f32 v68, v68, v106
  v_add_f32 v69, v69, v107
  v_lshlrev_b32 v106, 16, v127
  v_and_b32 v107, 0xffff0000, v127
  v_add_f32 v70, v70, v106
  v_add_f32 v71, v71, v107
  s_waitcnt vmcnt(4)
  v_lshlrev_b32 v106, 16, v128
  v_and_b32 v107, 0xffff0000, v128
  v_add_f32 v36, v36, v106
  v_add_f32 v37, v37, v107
  v_lshlrev_b32 v106, 16, v129
  v_and_b32 v107, 0xffff0000, v129
  v_add_f32 v38, v38, v106
  v_add_f32 v39, v39, v107
  v_lshlrev_b32 v106, 16, v130
  v_and_b32 v107, 0xffff0000, v130
  v_add_f32 v72, v72, v106
  v_add_f32 v73, v73, v107
  v_lshlrev_b32 v106, 16, v131
  v_and_b32 v107, 0xffff0000, v131
  v_add_f32 v74, v74, v106
  v_add_f32 v75, v75, v107
  s_waitcnt vmcnt(3)
  v_lshlrev_b32 v106, 16, v132
  v_and_b32 v107, 0xffff0000, v132
  v_add_f32 v40, v40, v106
  v_add_f32 v41, v41, v107
  v_lshlrev_b32 v106, 16, v133
  v_and_b32 v107, 0xffff0000, v133
  v_add_f32 v42, v42, v106
  v_add_f32 v43, v43, v107
  v_lshlrev_b32 v106, 16, v134
  v_and_b32 v107, 0xffff0000, v134
  v_add_f32 v76, v76, v106
  v_add_f32 v77, v77, v107
  v_lshlrev_b32 v106, 16, v135
  v_and_b32 v107, 0xffff0000, v135
  v_add_f32 v78, v78, v106
  v_add_f32 v79, v79, v107
  s_waitcnt vmcnt(2)
  v_lshlrev_b32 v106, 16, v136
  v_and_b32 v107, 0xffff0000, v136
  v_add_f32 v32, v32, v106
  v_add_f32 v33, v33, v107
  v_lshlrev_b32 v106, 16, v137
  v_and_b32 v107, 0xffff0000, v137
  v_add_f32 v34, v34, v106
  v_add_f32 v35, v35, v107
  v_lshlrev_b32 v106, 16, v138
  v_and_b32 v107, 0xffff0000, v138
  v_add_f32 v68, v68, v106
  v_add_f32 v69, v69, v107
  v_lshlrev_b32 v106, 16, v139
  v_and_b32 v107, 0xffff0000, v139
  v_add_f32 v70, v70, v106
  v_add_f32 v71, v71, v107
  s_waitcnt vmcnt(1)
  v_lshlrev_b32 v106, 16, v140
  v_and_b32 v107, 0xffff0000, v140
  v_add_f32 v36, v36, v106
  v_add_f32 v37, v37, v107
  v_lshlrev_b32 v106, 16, v141
  v_and_b32 v107, 0xffff0000, v141
  v_add_f32 v38, v38, v106
  v_add_f32 v39, v39, v107
  v_lshlrev_b32 v106, 16, v142
  v_and_b32 v107, 0xffff0000, v142
  v_add_f32 v72, v72, v106
  v_add_f32 v73, v73, v107
  v_lshlrev_b32 v106, 16, v143
  v_and_b32 v107, 0xffff0000, v143
  v_add_f32 v74, v74, v106
  v_add_f32 v75, v75, v107
  s_waitcnt vmcnt(0)
  v_lshlrev_b32 v106, 16, v144
  v_and_b32 v107, 0xffff0000, v144
  v_add_f32 v40, v40, v106
  v_add_f32 v41, v41, v107
  v_lshlrev_b32 v106, 16, v145
  v_and_b32 v107, 0xffff0000, v145
  v_add_f32 v42, v42, v106
  v_add_f32 v43, v43, v107
  v_lshlrev_b32 v106, 16, v146
  v_and_b32 v107, 0xffff0000, v146
  v_add_f32 v76, v76, v106
  v_add_f32 v77, v77, v107
  v_lshlrev_b32 v106, 16, v147
  v_and_b32 v107, 0xffff0000, v147
  v_add_f32 v78, v78, v106
  v_add_f32 v79, v79, v107
  v_cvt_pk_bf16_f32 v32, v32, v33
  v_cvt_pk_bf16_f32 v33, v34, v35
  v_cvt_pk_bf16_f32 v34, v68, v69
  v_cvt_pk_bf16_f32 v35, v70, v71
  s_add_u32 s48, s45, 0
  buffer_store_dwordx4 v[32:35], v25, s[12:15], s48 offen
  v_cvt_pk_bf16_f32 v36, v36, v37
  v_cvt_pk_bf16_f32 v37, v38, v39
  v_cvt_pk_bf16_f32 v38, v72, v73
  v_cvt_pk_bf16_f32 v39, v74, v75
  s_add_u32 s48, s45, 32768
  buffer_store_dwordx4 v[36:39], v25, s[12:15], s48 offen
  v_cvt_pk_bf16_f32 v40, v40, v41
  v_cvt_pk_bf16_f32 v41, v42, v43
  v_cvt_pk_bf16_f32 v42, v76, v77
  v_cvt_pk_bf16_f32 v43, v78, v79
  s_add_u32 s48, s45, 65536
  buffer_store_dwordx4 v[40:43], v25, s[12:15], s48 offen
  s_branch concat_heads__gqa_block_cached__mha_block_cached__near_ridge_kernel_ofin68
concat_heads__gqa_block_cached__mha_block_cached__near_ridge_kernel_oc165:
  s_cmp_eq_u32 s3, 0
  s_cbranch_scc0 concat_heads__gqa_block_cached__mha_block_cached__near_ridge_kernel_pe74
  s_mov_b64 exec, 15
  s_nop 4
  v_lshlrev_b32 v16, 3, v0
  v_add_u32 v16, s44, v16
  global_load_dwordx2 v[104:105], v16, s[54:55] sc1
  s_mov_b64 exec, -1
concat_heads__gqa_block_cached__mha_block_cached__near_ridge_kernel_pe74:
  v_cvt_pk_bf16_f32 v32, v32, v33
  v_cvt_pk_bf16_f32 v33, v34, v35
  v_cvt_pk_bf16_f32 v34, v68, v69
  v_cvt_pk_bf16_f32 v35, v70, v71
  s_add_u32 s48, s42, 0
  buffer_store_dwordx4 v[32:35], v26, s[4:7], s48 offen sc1
  v_cvt_pk_bf16_f32 v36, v36, v37
  v_cvt_pk_bf16_f32 v37, v38, v39
  v_cvt_pk_bf16_f32 v38, v72, v73
  v_cvt_pk_bf16_f32 v39, v74, v75
  s_add_u32 s48, s42, 8192
  buffer_store_dwordx4 v[36:39], v26, s[4:7], s48 offen sc1
  v_cvt_pk_bf16_f32 v40, v40, v41
  v_cvt_pk_bf16_f32 v41, v42, v43
  v_cvt_pk_bf16_f32 v42, v76, v77
  v_cvt_pk_bf16_f32 v43, v78, v79
  s_add_u32 s48, s42, 16384
  buffer_store_dwordx4 v[40:43], v26, s[4:7], s48 offen sc1
  v_cvt_pk_bf16_f32 v52, v52, v53
  v_cvt_pk_bf16_f32 v53, v54, v55
  v_cvt_pk_bf16_f32 v54, v88, v89
  v_cvt_pk_bf16_f32 v55, v90, v91
  s_add_u32 s48, s42, 40960
  buffer_store_dwordx4 v[52:55], v26, s[4:7], s48 offen sc1
  v_cvt_pk_bf16_f32 v56, v56, v57
  v_cvt_pk_bf16_f32 v57, v58, v59
  v_cvt_pk_bf16_f32 v58, v92, v93
  v_cvt_pk_bf16_f32 v59, v94, v95
  s_add_u32 s48, s42, 49152
  buffer_store_dwordx4 v[56:59], v26, s[4:7], s48 offen sc1
  v_cvt_pk_bf16_f32 v60, v60, v61
  v_cvt_pk_bf16_f32 v61, v62, v63
  v_cvt_pk_bf16_f32 v62, v96, v97
  v_cvt_pk_bf16_f32 v63, v98, v99
  s_add_u32 s48, s42, 57344
  buffer_store_dwordx4 v[60:63], v26, s[4:7], s48 offen sc1
  v_cvt_pk_bf16_f32 v64, v64, v65
  v_cvt_pk_bf16_f32 v65, v66, v67
  v_cvt_pk_bf16_f32 v66, v100, v101
  v_cvt_pk_bf16_f32 v67, v102, v103
  s_add_u32 s48, s42, 65536
  buffer_store_dwordx4 v[64:67], v26, s[4:7], s48 offen sc1
  s_waitcnt vmcnt(0)
  s_barrier
  s_cmp_eq_u32 s3, 0
  s_cbranch_scc0 concat_heads__gqa_block_cached__mha_block_cached__near_ridge_kernel_w175
  s_lshl_b32 s48, s46, 3
  s_add_u32 s48, s48, s44
  v_mov_b32 v27, s48
  v_mov_b32 v30, s88
  v_mov_b32 v31, s89
  s_mov_b64 exec, 1
  s_nop 4
  global_store_dwordx2 v27, v[30:31], s[54:55] sc1
  s_mov_b64 exec, -1
  s_mov_b64 exec, 15
  s_nop 4
  v_cmp_eq_u32 vcc, s88, v104
  v_cmp_eq_u32 s[56:57], s89, v105
  s_lshl_b32 s48, 1, s46
  s_nop 3
  s_and_b64 s[56:57], s[56:57], vcc
  s_or_b32 s56, s56, s48
  s_cmp_eq_u64 s[56:57], exec
  s_mov_b64 exec, -1
  s_cbranch_scc1 concat_heads__gqa_block_cached__mha_block_cached__near_ridge_kernel_pq76
  s_mov_b64 exec, 15
  s_nop 4
  v_lshlrev_b32 v27, 3, v0
  v_add_u32 v27, s44, v27
  s_mov_b32 s97, 0
concat_heads__gqa_block_cached__mha_block_cached__near_ridge_kernel_f2p77:
  global_load_dwordx2 v[30:31], v27, s[54:55] sc1
  s_waitcnt vmcnt(0)
  v_cmp_eq_u32 vcc, s88, v30
  v_cmp_eq_u32 s[56:57], s89, v31
  s_nop 3
  s_and_b64 s[56:57], s[56:57], vcc
  s_cmp_eq_u64 s[56:57], exec
  s_cbranch_scc1 concat_heads__gqa_block_cached__mha_block_cached__near_ridge_kernel_f2d78
  s_sleep 1
  s_add_u32 s97, s97, 1
  s_cmp_lt_u32 s97, 0x40000
  s_cbranch_scc1 concat_heads__gqa_block_cached__mha_block_cached__near_ridge_kernel_f2p77
concat_heads__gqa_block_cached__mha_block_cached__near_ridge_kernel_f2d78:
  s_mov_b64 exec, -1
concat_heads__gqa_block_cached__mha_block_cached__near_ridge_kernel_pq76:
concat_heads__gqa_block_cached__mha_block_cached__near_ridge_kernel_w175:
  s_barrier
  s_mov_b32 s48, 172032
  buffer_load_dwordx4 v[112:115], v26, s[4:7], s48 offen offset:0 sc1
  s_mov_b32 s48, 180224
  buffer_load_dwordx4 v[116:119], v26, s[4:7], s48 offen offset:0 sc1
  s_mov_b32 s48, 245760
  buffer_load_dwordx4 v[120:123], v26, s[4:7], s48 offen offset:0 sc1
  s_mov_b32 s48, 253952
  buffer_load_dwordx4 v[124:127], v26, s[4:7], s48 offen offset:0 sc1
  s_mov_b32 s48, 24576
  buffer_load_dwordx4 v[128:131], v26, s[4:7], s48 offen offset:0 sc1
  s_mov_b32 s48, 32768
  buffer_load_dwordx4 v[132:135], v26, s[4:7], s48 offen offset:0 sc1
  s_waitcnt vmcnt(5)
  v_lshlrev_b32 v106, 16, v112
  v_and_b32 v107, 0xffff0000, v112
  v_add_f32 v44, v44, v106
  v_add_f32 v45, v45, v107
  v_lshlrev_b32 v106, 16, v113
  v_and_b32 v107, 0xffff0000, v113
  v_add_f32 v46, v46, v106
  v_add_f32 v47, v47, v107
  v_lshlrev_b32 v106, 16, v114
  v_and_b32 v107, 0xffff0000, v114
  v_add_f32 v80, v80, v106
  v_add_f32 v81, v81, v107
  v_lshlrev_b32 v106, 16, v115
  v_and_b32 v107, 0xffff0000, v115
  v_add_f32 v82, v82, v106
  v_add_f32 v83, v83, v107
  s_waitcnt vmcnt(4)
  v_lshlrev_b32 v106, 16, v116
  v_and_b32 v107, 0xffff0000, v116
  v_add_f32 v48, v48, v106
  v_add_f32 v49, v49, v107
  v_lshlrev_b32 v106, 16, v117
  v_and_b32 v107, 0xffff0000, v117
  v_add_f32 v50, v50, v106
  v_add_f32 v51, v51, v107
  v_lshlrev_b32 v106, 16, v118
  v_and_b32 v107, 0xffff0000, v118
  v_add_f32 v84, v84, v106
  v_add_f32 v85, v85, v107
  v_lshlrev_b32 v106, 16, v119
  v_and_b32 v107, 0xffff0000, v119
  v_add_f32 v86, v86, v106
  v_add_f32 v87, v87, v107
  s_waitcnt vmcnt(3)
  v_lshlrev_b32 v106, 16, v120
  v_and_b32 v107, 0xffff0000, v120
  v_add_f32 v44, v44, v106
  v_add_f32 v45, v45, v107
  v_lshlrev_b32 v106, 16, v121
  v_and_b32 v107, 0xffff0000, v121
  v_add_f32 v46, v46, v106
  v_add_f32 v47, v47, v107
  v_lshlrev_b32 v106, 16, v122
  v_and_b32 v107, 0xffff0000, v122
  v_add_f32 v80, v80, v106
  v_add_f32 v81, v81, v107
  v_lshlrev_b32 v106, 16, v123
  v_and_b32 v107, 0xffff0000, v123
  v_add_f32 v82, v82, v106
  v_add_f32 v83, v83, v107
  s_waitcnt vmcnt(2)
  v_lshlrev_b32 v106, 16, v124
  v_and_b32 v107, 0xffff0000, v124
  v_add_f32 v48, v48, v106
  v_add_f32 v49, v49, v107
  v_lshlrev_b32 v106, 16, v125
  v_and_b32 v107, 0xffff0000, v125
  v_add_f32 v50, v50, v106
  v_add_f32 v51, v51, v107
  v_lshlrev_b32 v106, 16, v126
  v_and_b32 v107, 0xffff0000, v126
  v_add_f32 v84, v84, v106
  v_add_f32 v85, v85, v107
  v_lshlrev_b32 v106, 16, v127
  v_and_b32 v107, 0xffff0000, v127
  v_add_f32 v86, v86, v106
  v_add_f32 v87, v87, v107
  s_waitcnt vmcnt(1)
  v_lshlrev_b32 v106, 16, v128
  v_and_b32 v107, 0xffff0000, v128
  v_add_f32 v44, v44, v106
  v_add_f32 v45, v45, v107
  v_lshlrev_b32 v106, 16, v129
  v_and_b32 v107, 0xffff0000, v129
  v_add_f32 v46, v46, v106
  v_add_f32 v47, v47, v107
  v_lshlrev_b32 v106, 16, v130
  v_and_b32 v107, 0xffff0000, v130
  v_add_f32 v80, v80, v106
  v_add_f32 v81, v81, v107
  v_lshlrev_b32 v106, 16, v131
  v_and_b32 v107, 0xffff0000, v131
  v_add_f32 v82, v82, v106
  v_add_f32 v83, v83, v107
  s_waitcnt vmcnt(0)
  v_lshlrev_b32 v106, 16, v132
  v_and_b32 v107, 0xffff0000, v132
  v_add_f32 v48, v48, v106
  v_add_f32 v49, v49, v107
  v_lshlrev_b32 v106, 16, v133
  v_and_b32 v107, 0xffff0000, v133
  v_add_f32 v50, v50, v106
  v_add_f32 v51, v51, v107
  v_lshlrev_b32 v106, 16, v134
  v_and_b32 v107, 0xffff0000, v134
  v_add_f32 v84, v84, v106
  v_add_f32 v85, v85, v107
  v_lshlrev_b32 v106, 16, v135
  v_and_b32 v107, 0xffff0000, v135
  v_add_f32 v86, v86, v106
  v_add_f32 v87, v87, v107
  v_cvt_pk_bf16_f32 v44, v44, v45
  v_cvt_pk_bf16_f32 v45, v46, v47
  v_cvt_pk_bf16_f32 v46, v80, v81
  v_cvt_pk_bf16_f32 v47, v82, v83
  s_add_u32 s48, s45, 98304
  buffer_store_dwordx4 v[44:47], v25, s[12:15], s48 offen
  v_cvt_pk_bf16_f32 v48, v48, v49
  v_cvt_pk_bf16_f32 v49, v50, v51
  v_cvt_pk_bf16_f32 v50, v84, v85
  v_cvt_pk_bf16_f32 v51, v86, v87
  s_add_u32 s48, s45, 131072
  buffer_store_dwordx4 v[48:51], v25, s[12:15], s48 offen
  s_branch concat_heads__gqa_block_cached__mha_block_cached__near_ridge_kernel_ofin68
concat_heads__gqa_block_cached__mha_block_cached__near_ridge_kernel_oc266:
  s_cmp_eq_u32 s3, 0
  s_cbranch_scc0 concat_heads__gqa_block_cached__mha_block_cached__near_ridge_kernel_pe79
  s_mov_b64 exec, 15
  s_nop 4
  v_lshlrev_b32 v16, 3, v0
  v_add_u32 v16, s44, v16
  global_load_dwordx2 v[104:105], v16, s[54:55] sc1
  s_mov_b64 exec, -1
concat_heads__gqa_block_cached__mha_block_cached__near_ridge_kernel_pe79:
  v_cvt_pk_bf16_f32 v32, v32, v33
  v_cvt_pk_bf16_f32 v33, v34, v35
  v_cvt_pk_bf16_f32 v34, v68, v69
  v_cvt_pk_bf16_f32 v35, v70, v71
  s_add_u32 s48, s42, 0
  buffer_store_dwordx4 v[32:35], v26, s[4:7], s48 offen sc1
  v_cvt_pk_bf16_f32 v36, v36, v37
  v_cvt_pk_bf16_f32 v37, v38, v39
  v_cvt_pk_bf16_f32 v38, v72, v73
  v_cvt_pk_bf16_f32 v39, v74, v75
  s_add_u32 s48, s42, 8192
  buffer_store_dwordx4 v[36:39], v26, s[4:7], s48 offen sc1
  v_cvt_pk_bf16_f32 v40, v40, v41
  v_cvt_pk_bf16_f32 v41, v42, v43
  v_cvt_pk_bf16_f32 v42, v76, v77
  v_cvt_pk_bf16_f32 v43, v78, v79
  s_add_u32 s48, s42, 16384
  buffer_store_dwordx4 v[40:43], v26, s[4:7], s48 offen sc1
  v_cvt_pk_bf16_f32 v44, v44, v45
  v_cvt_pk_bf16_f32 v45, v46, v47
  v_cvt_pk_bf16_f32 v46, v80, v81
  v_cvt_pk_bf16_f32 v47, v82, v83
  s_add_u32 s48, s42, 24576
  buffer_store_dwordx4 v[44:47], v26, s[4:7], s48 offen sc1
  v_cvt_pk_bf16_f32 v48, v48, v49
  v_cvt_pk_bf16_f32 v49, v50, v51
  v_cvt_pk_bf16_f32 v50, v84, v85
  v_cvt_pk_bf16_f32 v51, v86, v87
  s_add_u32 s48, s42, 32768
  buffer_store_dwordx4 v[48:51], v26, s[4:7], s48 offen sc1
  v_cvt_pk_bf16_f32 v60, v60, v61
  v_cvt_pk_bf16_f32 v61, v62, v63
  v_cvt_pk_bf16_f32 v62, v96, v97
  v_cvt_pk_bf16_f32 v63, v98, v99
  s_add_u32 s48, s42, 57344
  buffer_store_dwordx4 v[60:63], v26, s[4:7], s48 offen sc1
  v_cvt_pk_bf16_f32 v64, v64, v65
  v_cvt_pk_bf16_f32 v65, v66, v67
  v_cvt_pk_bf16_f32 v66, v100, v101
  v_cvt_pk_bf16_f32 v67, v102, v103
  s_add_u32 s48, s42, 65536
  buffer_store_dwordx4 v[64:67], v26, s[4:7], s48 offen sc1
  s_waitcnt vmcnt(0)
  s_barrier
  s_cmp_eq_u32 s3, 0
  s_cbranch_scc0 concat_heads__gqa_block_cached__mha_block_cached__near_ridge_kernel_w180
  s_lshl_b32 s48, s46, 3
  s_add_u32 s48, s48, s44
  v_mov_b32 v27, s48
  v_mov_b32 v30, s88
  v_mov_b32 v31, s89
  s_mov_b64 exec, 1
  s_nop 4
  global_store_dwordx2 v27, v[30:31], s[54:55] sc1
  s_mov_b64 exec, -1
  s_mov_b64 exec, 15
  s_nop 4
  v_cmp_eq_u32 vcc, s88, v104
  v_cmp_eq_u32 s[56:57], s89, v105
  s_lshl_b32 s48, 1, s46
  s_nop 3
  s_and_b64 s[56:57], s[56:57], vcc
  s_or_b32 s56, s56, s48
  s_cmp_eq_u64 s[56:57], exec
  s_mov_b64 exec, -1
  s_cbranch_scc1 concat_heads__gqa_block_cached__mha_block_cached__near_ridge_kernel_pq81
  s_mov_b64 exec, 15
  s_nop 4
  v_lshlrev_b32 v27, 3, v0
  v_add_u32 v27, s44, v27
  s_mov_b32 s97, 0
concat_heads__gqa_block_cached__mha_block_cached__near_ridge_kernel_f2p82:
  global_load_dwordx2 v[30:31], v27, s[54:55] sc1
  s_waitcnt vmcnt(0)
  v_cmp_eq_u32 vcc, s88, v30
  v_cmp_eq_u32 s[56:57], s89, v31
  s_nop 3
  s_and_b64 s[56:57], s[56:57], vcc
  s_cmp_eq_u64 s[56:57], exec
  s_cbranch_scc1 concat_heads__gqa_block_cached__mha_block_cached__near_ridge_kernel_f2d83
  s_sleep 1
  s_add_u32 s97, s97, 1
  s_cmp_lt_u32 s97, 0x40000
  s_cbranch_scc1 concat_heads__gqa_block_cached__mha_block_cached__near_ridge_kernel_f2p82
concat_heads__gqa_block_cached__mha_block_cached__near_ridge_kernel_f2d83:
  s_mov_b64 exec, -1
concat_heads__gqa_block_cached__mha_block_cached__near_ridge_kernel_pq81:
concat_heads__gqa_block_cached__mha_block_cached__near_ridge_kernel_w180:
  s_barrier
  s_mov_b32 s48, 262144
  buffer_load_dwordx4 v[112:115], v26, s[4:7], s48 offen offset:0 sc1
  s_mov_b32 s48, 270336
  buffer_load_dwordx4 v[116:119], v26, s[4:7], s48 offen offset:0 sc1
  s_mov_b32 s48, 40960
  buffer_load_dwordx4 v[120:123], v26, s[4:7], s48 offen offset:0 sc1
  s_mov_b32 s48, 49152
  buffer_load_dwordx4 v[124:127], v26, s[4:7], s48 offen offset:0 sc1
  s_mov_b32 s48, 114688
  buffer_load_dwordx4 v[128:131], v26, s[4:7], s48 offen offset:0 sc1
  s_mov_b32 s48, 122880
  buffer_load_dwordx4 v[132:135], v26, s[4:7], s48 offen offset:0 sc1
  s_waitcnt vmcnt(5)
  v_lshlrev_b32 v106, 16, v112
  v_and_b32 v107, 0xffff0000, v112
  v_add_f32 v52, v52, v106
  v_add_f32 v53, v53, v107
  v_lshlrev_b32 v106, 16, v113
  v_and_b32 v107, 0xffff0000, v113
  v_add_f32 v54, v54, v106
  v_add_f32 v55, v55, v107
  v_lshlrev_b32 v106, 16, v114
  v_and_b32 v107, 0xffff0000, v114
  v_add_f32 v88, v88, v106
  v_add_f32 v89, v89, v107
  v_lshlrev_b32 v106, 16, v115
  v_and_b32 v107, 0xffff0000, v115
  v_add_f32 v90, v90, v106
  v_add_f32 v91, v91, v107
  s_waitcnt vmcnt(4)
  v_lshlrev_b32 v106, 16, v116
  v_and_b32 v107, 0xffff0000, v116
  v_add_f32 v56, v56, v106
  v_add_f32 v57, v57, v107
  v_lshlrev_b32 v106, 16, v117
  v_and_b32 v107, 0xffff0000, v117
  v_add_f32 v58, v58, v106
  v_add_f32 v59, v59, v107
  v_lshlrev_b32 v106, 16, v118
  v_and_b32 v107, 0xffff0000, v118
  v_add_f32 v92, v92, v106
  v_add_f32 v93, v93, v107
  v_lshlrev_b32 v106, 16, v119
  v_and_b32 v107, 0xffff0000, v119
  v_add_f32 v94, v94, v106
  v_add_f32 v95, v95, v107
  s_waitcnt vmcnt(3)
  v_lshlrev_b32 v106, 16, v120
  v_and_b32 v107, 0xffff0000, v120
  v_add_f32 v52, v52, v106
  v_add_f32 v53, v53, v107
  v_lshlrev_b32 v106, 16, v121
  v_and_b32 v107, 0xffff0000, v121
  v_add_f32 v54, v54, v106
  v_add_f32 v55, v55, v107
  v_lshlrev_b32 v106, 16, v122
  v_and_b32 v107, 0xffff0000, v122
  v_add_f32 v88, v88, v106
  v_add_f32 v89, v89, v107
  v_lshlrev_b32 v106, 16, v123
  v_and_b32 v107, 0xffff0000, v123
  v_add_f32 v90, v90, v106
  v_add_f32 v91, v91, v107
  s_waitcnt vmcnt(2)
  v_lshlrev_b32 v106, 16, v124
  v_and_b32 v107, 0xffff0000, v124
  v_add_f32 v56, v56, v106
  v_add_f32 v57, v57, v107
  v_lshlrev_b32 v106, 16, v125
  v_and_b32 v107, 0xffff0000, v125
  v_add_f32 v58, v58, v106
  v_add_f32 v59, v59, v107
  v_lshlrev_b32 v106, 16, v126
  v_and_b32 v107, 0xffff0000, v126
  v_add_f32 v92, v92, v106
  v_add_f32 v93, v93, v107
  v_lshlrev_b32 v106, 16, v127
  v_and_b32 v107, 0xffff0000, v127
  v_add_f32 v94, v94, v106
  v_add_f32 v95, v95, v107
  s_waitcnt vmcnt(1)
  v_lshlrev_b32 v106, 16, v128
  v_and_b32 v107, 0xffff0000, v128
  v_add_f32 v52, v52, v106
  v_add_f32 v53, v53, v107
  v_lshlrev_b32 v106, 16, v129
  v_and_b32 v107, 0xffff0000, v129
  v_add_f32 v54, v54, v106
  v_add_f32 v55, v55, v107
  v_lshlrev_b32 v106, 16, v130
  v_and_b32 v107, 0xffff0000, v130
  v_add_f32 v88, v88, v106
  v_add_f32 v89, v89, v107
  v_lshlrev_b32 v106, 16, v131
  v_and_b32 v107, 0xffff0000, v131
  v_add_f32 v90, v90, v106
  v_add_f32 v91, v91, v107
  s_waitcnt vmcnt(0)
  v_lshlrev_b32 v106, 16, v132
  v_and_b32 v107, 0xffff0000, v132
  v_add_f32 v56, v56, v106
  v_add_f32 v57, v57, v107
  v_lshlrev_b32 v106, 16, v133
  v_and_b32 v107, 0xffff0000, v133
  v_add_f32 v58, v58, v106
  v_add_f32 v59, v59, v107
  v_lshlrev_b32 v106, 16, v134
  v_and_b32 v107, 0xffff0000, v134
  v_add_f32 v92, v92, v106
  v_add_f32 v93, v93, v107
  v_lshlrev_b32 v106, 16, v135
  v_and_b32 v107, 0xffff0000, v135
  v_add_f32 v94, v94, v106
  v_add_f32 v95, v95, v107
  v_cvt_pk_bf16_f32 v52, v52, v53
  v_cvt_pk_bf16_f32 v53, v54, v55
  v_cvt_pk_bf16_f32 v54, v88, v89
  v_cvt_pk_bf16_f32 v55, v90, v91
  s_add_u32 s48, s45, 163840
  buffer_store_dwordx4 v[52:55], v25, s[12:15], s48 offen
  v_cvt_pk_bf16_f32 v56, v56, v57
  v_cvt_pk_bf16_f32 v57, v58, v59
  v_cvt_pk_bf16_f32 v58, v92, v93
  v_cvt_pk_bf16_f32 v59, v94, v95
  s_add_u32 s48, s45, 196608
  buffer_store_dwordx4 v[56:59], v25, s[12:15], s48 offen
  s_branch concat_heads__gqa_block_cached__mha_block_cached__near_ridge_kernel_ofin68
concat_heads__gqa_block_cached__mha_block_cached__near_ridge_kernel_oc367:
  s_cmp_eq_u32 s3, 0
  s_cbranch_scc0 concat_heads__gqa_block_cached__mha_block_cached__near_ridge_kernel_pe84
  s_mov_b64 exec, 15
  s_nop 4
  v_lshlrev_b32 v16, 3, v0
  v_add_u32 v16, s44, v16
  global_load_dwordx2 v[104:105], v16, s[54:55] sc1
  s_mov_b64 exec, -1
concat_heads__gqa_block_cached__mha_block_cached__near_ridge_kernel_pe84:
  v_cvt_pk_bf16_f32 v32, v32, v33
  v_cvt_pk_bf16_f32 v33, v34, v35
  v_cvt_pk_bf16_f32 v34, v68, v69
  v_cvt_pk_bf16_f32 v35, v70, v71
  s_add_u32 s48, s42, 0
  buffer_store_dwordx4 v[32:35], v26, s[4:7], s48 offen sc1
  v_cvt_pk_bf16_f32 v36, v36, v37
  v_cvt_pk_bf16_f32 v37, v38, v39
  v_cvt_pk_bf16_f32 v38, v72, v73
  v_cvt_pk_bf16_f32 v39, v74, v75
  s_add_u32 s48, s42, 8192
  buffer_store_dwordx4 v[36:39], v26, s[4:7], s48 offen sc1
  v_cvt_pk_bf16_f32 v40, v40, v41
  v_cvt_pk_bf16_f32 v41, v42, v43
  v_cvt_pk_bf16_f32 v42, v76, v77
  v_cvt_pk_bf16_f32 v43, v78, v79
  s_add_u32 s48, s42, 16384
  buffer_store_dwordx4 v[40:43], v26, s[4:7], s48 offen sc1
  v_cvt_pk_bf16_f32 v44, v44, v45
  v_cvt_pk_bf16_f32 v45, v46, v47
  v_cvt_pk_bf16_f32 v46, v80, v81
  v_cvt_pk_bf16_f32 v47, v82, v83
  s_add_u32 s48, s42, 24576
  buffer_store_dwordx4 v[44:47], v26, s[4:7], s48 offen sc1
  v_cvt_pk_bf16_f32 v48, v48, v49
  v_cvt_pk_bf16_f32 v49, v50, v51
  v_cvt_pk_bf16_f32 v50, v84, v85
  v_cvt_pk_bf16_f32 v51, v86, v87
  s_add_u32 s48, s42, 32768
  buffer_store_dwordx4 v[48:51], v26, s[4:7], s48 offen sc1
  v_cvt_pk_bf16_f32 v52, v52, v53
  v_cvt_pk_bf16_f32 v53, v54, v55
  v_cvt_pk_bf16_f32 v54, v88, v89
  v_cvt_pk_bf16_f32 v55, v90, v91
  s_add_u32 s48, s42, 40960
  buffer_store_dwordx4 v[52:55], v26, s[4:7], s48 offen sc1
  v_cvt_pk_bf16_f32 v56, v56, v57
  v_cvt_pk_bf16_f32 v57, v58, v59
  v_cvt_pk_bf16_f32 v58, v92, v93
  v_cvt_pk_bf16_f32 v59, v94, v95
  s_add_u32 s48, s42, 49152
  buffer_store_dwordx4 v[56:59], v26, s[4:7], s48 offen sc1
  s_waitcnt vmcnt(0)
  s_barrier
  s_cmp_eq_u32 s3, 0
  s_cbranch_scc0 concat_heads__gqa_block_cached__mha_block_cached__near_ridge_kernel_w185
  s_lshl_b32 s48, s46, 3
  s_add_u32 s48, s48, s44
  v_mov_b32 v27, s48
  v_mov_b32 v30, s88
  v_mov_b32 v31, s89
  s_mov_b64 exec, 1
  s_nop 4
  global_store_dwordx2 v27, v[30:31], s[54:55] sc1
  s_mov_b64 exec, -1
  s_mov_b64 exec, 15
  s_nop 4
  v_cmp_eq_u32 vcc, s88, v104
  v_cmp_eq_u32 s[56:57], s89, v105
  s_lshl_b32 s48, 1, s46
  s_nop 3
  s_and_b64 s[56:57], s[56:57], vcc
  s_or_b32 s56, s56, s48
  s_cmp_eq_u64 s[56:57], exec
  s_mov_b64 exec, -1
  s_cbranch_scc1 concat_heads__gqa_block_cached__mha_block_cached__near_ridge_kernel_pq86
  s_mov_b64 exec, 15
  s_nop 4
  v_lshlrev_b32 v27, 3, v0
  v_add_u32 v27, s44, v27
  s_mov_b32 s97, 0
concat_heads__gqa_block_cached__mha_block_cached__near_ridge_kernel_f2p87:
  global_load_dwordx2 v[30:31], v27, s[54:55] sc1
  s_waitcnt vmcnt(0)
  v_cmp_eq_u32 vcc, s88, v30
  v_cmp_eq_u32 s[56:57], s89, v31
  s_nop 3
  s_and_b64 s[56:57], s[56:57], vcc
  s_cmp_eq_u64 s[56:57], exec
  s_cbranch_scc1 concat_heads__gqa_block_cached__mha_block_cached__near_ridge_kernel_f2d88
  s_sleep 1
  s_add_u32 s97, s97, 1
  s_cmp_lt_u32 s97, 0x40000
  s_cbranch_scc1 concat_heads__gqa_block_cached__mha_block_cached__near_ridge_kernel_f2p87
concat_heads__gqa_block_cached__mha_block_cached__near_ridge_kernel_f2d88:
  s_mov_b64 exec, -1
concat_heads__gqa_block_cached__mha_block_cached__near_ridge_kernel_pq86:
concat_heads__gqa_block_cached__mha_block_cached__near_ridge_kernel_w185:
  s_barrier
  s_mov_b32 s48, 57344
  buffer_load_dwordx4 v[112:115], v26, s[4:7], s48 offen offset:0 sc1
  s_mov_b32 s48, 65536
  buffer_load_dwordx4 v[116:119], v26, s[4:7], s48 offen offset:0 sc1
  s_mov_b32 s48, 131072
  buffer_load_dwordx4 v[120:123], v26, s[4:7], s48 offen offset:0 sc1
  s_mov_b32 s48, 139264
  buffer_load_dwordx4 v[124:127], v26, s[4:7], s48 offen offset:0 sc1
  s_mov_b32 s48, 204800
  buffer_load_dwordx4 v[128:131], v26, s[4:7], s48 offen offset:0 sc1
  s_mov_b32 s48, 212992
  buffer_load_dwordx4 v[132:135], v26, s[4:7], s48 offen offset:0 sc1
  s_waitcnt vmcnt(5)
  v_lshlrev_b32 v106, 16, v112
  v_and_b32 v107, 0xffff0000, v112
  v_add_f32 v60, v60, v106
  v_add_f32 v61, v61, v107
  v_lshlrev_b32 v106, 16, v113
  v_and_b32 v107, 0xffff0000, v113
  v_add_f32 v62, v62, v106
  v_add_f32 v63, v63, v107
  v_lshlrev_b32 v106, 16, v114
  v_and_b32 v107, 0xffff0000, v114
  v_add_f32 v96, v96, v106
  v_add_f32 v97, v97, v107
  v_lshlrev_b32 v106, 16, v115
  v_and_b32 v107, 0xffff0000, v115
  v_add_f32 v98, v98, v106
  v_add_f32 v99, v99, v107
  s_waitcnt vmcnt(4)
  v_lshlrev_b32 v106, 16, v116
  v_and_b32 v107, 0xffff0000, v116
  v_add_f32 v64, v64, v106
  v_add_f32 v65, v65, v107
  v_lshlrev_b32 v106, 16, v117
  v_and_b32 v107, 0xffff0000, v117
  v_add_f32 v66, v66, v106
  v_add_f32 v67, v67, v107
  v_lshlrev_b32 v106, 16, v118
  v_and_b32 v107, 0xffff0000, v118
  v_add_f32 v100, v100, v106
  v_add_f32 v101, v101, v107
  v_lshlrev_b32 v106, 16, v119
  v_and_b32 v107, 0xffff0000, v119
  v_add_f32 v102, v102, v106
  v_add_f32 v103, v103, v107
  s_waitcnt vmcnt(3)
  v_lshlrev_b32 v106, 16, v120
  v_and_b32 v107, 0xffff0000, v120
  v_add_f32 v60, v60, v106
  v_add_f32 v61, v61, v107
  v_lshlrev_b32 v106, 16, v121
  v_and_b32 v107, 0xffff0000, v121
  v_add_f32 v62, v62, v106
  v_add_f32 v63, v63, v107
  v_lshlrev_b32 v106, 16, v122
  v_and_b32 v107, 0xffff0000, v122
  v_add_f32 v96, v96, v106
  v_add_f32 v97, v97, v107
  v_lshlrev_b32 v106, 16, v123
  v_and_b32 v107, 0xffff0000, v123
  v_add_f32 v98, v98, v106
  v_add_f32 v99, v99, v107
  s_waitcnt vmcnt(2)
  v_lshlrev_b32 v106, 16, v124
  v_and_b32 v107, 0xffff0000, v124
  v_add_f32 v64, v64, v106
  v_add_f32 v65, v65, v107
  v_lshlrev_b32 v106, 16, v125
  v_and_b32 v107, 0xffff0000, v125
  v_add_f32 v66, v66, v106
  v_add_f32 v67, v67, v107
  v_lshlrev_b32 v106, 16, v126
  v_and_b32 v107, 0xffff0000, v126
  v_add_f32 v100, v100, v106
  v_add_f32 v101, v101, v107
  v_lshlrev_b32 v106, 16, v127
  v_and_b32 v107, 0xffff0000, v127
  v_add_f32 v102, v102, v106
  v_add_f32 v103, v103, v107
  s_waitcnt vmcnt(1)
  v_lshlrev_b32 v106, 16, v128
  v_and_b32 v107, 0xffff0000, v128
  v_add_f32 v60, v60, v106
  v_add_f32 v61, v61, v107
  v_lshlrev_b32 v106, 16, v129
  v_and_b32 v107, 0xffff0000, v129
  v_add_f32 v62, v62, v106
  v_add_f32 v63, v63, v107
  v_lshlrev_b32 v106, 16, v130
  v_and_b32 v107, 0xffff0000, v130
  v_add_f32 v96, v96, v106
  v_add_f32 v97, v97, v107
  v_lshlrev_b32 v106, 16, v131
  v_and_b32 v107, 0xffff0000, v131
  v_add_f32 v98, v98, v106
  v_add_f32 v99, v99, v107
  s_waitcnt vmcnt(0)
  v_lshlrev_b32 v106, 16, v132
  v_and_b32 v107, 0xffff0000, v132
  v_add_f32 v64, v64, v106
  v_add_f32 v65, v65, v107
  v_lshlrev_b32 v106, 16, v133
  v_and_b32 v107, 0xffff0000, v133
  v_add_f32 v66, v66, v106
  v_add_f32 v67, v67, v107
  v_lshlrev_b32 v106, 16, v134
  v_and_b32 v107, 0xffff0000, v134
  v_add_f32 v100, v100, v106
  v_add_f32 v101, v101, v107
  v_lshlrev_b32 v106, 16, v135
  v_and_b32 v107, 0xffff0000, v135
  v_add_f32 v102, v102, v106
  v_add_f32 v103, v103, v107
  v_cvt_pk_bf16_f32 v60, v60, v61
  v_cvt_pk_bf16_f32 v61, v62, v63
  v_cvt_pk_bf16_f32 v62, v96, v97
  v_cvt_pk_bf16_f32 v63, v98, v99
  s_add_u32 s48, s45, 229376
  buffer_store_dwordx4 v[60:63], v25, s[12:15], s48 offen
  v_cvt_pk_bf16_f32 v64, v64, v65
  v_cvt_pk_bf16_f32 v65, v66, v67
  v_cvt_pk_bf16_f32 v66, v100, v101
  v_cvt_pk_bf16_f32 v67, v102, v103
  s_add_u32 s48, s45, 262144
  buffer_store_dwordx4 v[64:67], v25, s[12:15], s48 offen
concat_heads__gqa_block_cached__mha_block_cached__near_ridge_kernel_ofin68:
  s_waitcnt vmcnt(0)
  s_branch concat_heads__gqa_block_cached__mha_block_cached__near_ridge_kernel_done
concat_heads__gqa_block_cached__mha_block_cached__near_ridge_kernel_fallback:
  s_mov_b32 s51, 1
  s_waitcnt vmcnt(0)
  s_barrier
  s_mul_i32 s48, s35, 32768
  v_subrev_u32 v5, s48, v5
  v_subrev_u32 v6, s48, v6
  v_subrev_u32 v7, s48, v7
  v_subrev_u32 v8, s48, v8
  v_subrev_u32 v9, s48, v9
  v_subrev_u32 v10, s48, v10
  v_subrev_u32 v11, s48, v11
  v_subrev_u32 v12, s48, v12
  v_subrev_u32 v13, s48, v13
  v_subrev_u32 v14, s48, v14
  v_subrev_u32 v15, s48, v15
  v_subrev_u32 v16, s48, v16
  v_mov_b32 v216, 0xff800000
  v_mov_b32 v217, 0xff800000
  v_mov_b32 v218, 0xff800000
  v_mov_b32 v219, 0xff800000
  v_mov_b32 v220, 0xff800000
  s_mov_b32 s30, 0
  s_mov_b32 s32, s40
concat_heads__gqa_block_cached__mha_block_cached__near_ridge_kernel_mx:
  s_add_u32 m0, s39, 0
  s_add_u32 s37, s32, 0
  buffer_load_dwordx4 v1, s[12:15], s37 offen nt lds
  buffer_load_dwordx4 v2, s[12:15], s37 offen offset:1024 nt lds
  s_add_u32 m0, s39, 8192
  s_add_u32 s37, s32, 131072
  buffer_load_dwordx4 v1, s[12:15], s37 offen nt lds
  buffer_load_dwordx4 v2, s[12:15], s37 offen offset:1024 nt lds
  s_waitcnt vmcnt(0)
  s_barrier
  ds_read_b128 a[100:103], v5 offset:0
  ds_read_b128 a[104:107], v6 offset:0
  ds_read_b128 a[108:111], v7 offset:0
  ds_read_b128 a[112:115], v8 offset:0
  ds_read_b128 a[116:119], v5 offset:4096
  ds_read_b128 a[120:123], v6 offset:4096
  ds_read_b128 a[124:127], v7 offset:4096
  ds_read_b128 a[128:131], v8 offset:4096
  s_waitcnt lgkmcnt(7)
  v_mfma_f32_16x16x32_bf16 v[192:195], a[100:103], a[0:3], 0
  s_waitcnt lgkmcnt(3)
  v_mfma_f32_16x16x32_bf16 v[196:199], a[116:119], a[0:3], 0
  v_mfma_f32_16x16x32_bf16 v[192:195], a[104:107], a[4:7], v[192:195]
  s_waitcnt lgkmcnt(2)
  v_mfma_f32_16x16x32_bf16 v[196:199], a[120:123], a[4:7], v[196:199]
  v_mfma_f32_16x16x32_bf16 v[192:195], a[108:111], a[8:11], v[192:195]
  s_waitcnt lgkmcnt(1)
  v_mfma_f32_16x16x32_bf16 v[196:199], a[124:127], a[8:11], v[196:199]
  v_mfma_f32_16x16x32_bf16 v[192:195], a[112:115], a[12:15], v[192:195]
  s_waitcnt lgkmcnt(0)
  v_mfma_f32_16x16x32_bf16 v[196:199], a[128:131], a[12:15], v[196:199]
  s_nop 5
  v_max3_f32 v216, v192, v193, v216
  v_max3_f32 v216, v194, v195, v216
  v_max3_f32 v216, v196, v197, v216
  v_max3_f32 v216, v198, v199, v216
  v_mfma_f32_16x16x32_bf16 v[192:195], a[100:103], a[16:19], 0
  v_mfma_f32_16x16x32_bf16 v[196:199], a[116:119], a[16:19], 0
  v_mfma_f32_16x16x32_bf16 v[192:195], a[104:107], a[20:23], v[192:195]
  v_mfma_f32_16x16x32_bf16 v[196:199], a[120:123], a[20:23], v[196:199]
  v_mfma_f32_16x16x32_bf16 v[192:195], a[108:111], a[24:27], v[192:195]
  v_mfma_f32_16x16x32_bf16 v[196:199], a[124:127], a[24:27], v[196:199]
  v_mfma_f32_16x16x32_bf16 v[192:195], a[112:115], a[28:31], v[192:195]
  v_mfma_f32_16x16x32_bf16 v[196:199], a[128:131], a[28:31], v[196:199]
  s_nop 6
  v_max3_f32 v217, v192, v193, v217
  v_max3_f32 v217, v194, v195, v217
  v_max3_f32 v217, v196, v197, v217
  v_max3_f32 v217, v198, v199, v217
  v_mfma_f32_16x16x32_bf16 v[192:195], a[100:103], a[32:35], 0
  v_mfma_f32_16x16x32_bf16 v[196:199], a[116:119], a[32:35], 0
  v_mfma_f32_16x16x32_bf16 v[192:195], a[104:107], a[36:39], v[192:195]
  v_mfma_f32_16x16x32_bf16 v[196:199], a[120:123], a[36:39], v[196:199]
  v_mfma_f32_16x16x32_bf16 v[192:195], a[108:111], a[40:43], v[192:195]
  v_mfma_f32_16x16x32_bf16 v[196:199], a[124:127], a[40:43], v[196:199]
  v_mfma_f32_16x16x32_bf16 v[192:195], a[112:115], a[44:47], v[192:195]
  v_mfma_f32_16x16x32_bf16 v[196:199], a[128:131], a[44:47], v[196:199]
  s_nop 6
  v_max3_f32 v218, v192, v193, v218
  v_max3_f32 v218, v194, v195, v218
  v_max3_f32 v218, v196, v197, v218
  v_max3_f32 v218, v198, v199, v218
  v_mfma_f32_16x16x32_bf16 v[192:195], a[100:103], a[48:51], 0
  v_mfma_f32_16x16x32_bf16 v[196:199], a[116:119], a[48:51], 0
  v_mfma_f32_16x16x32_bf16 v[192:195], a[104:107], a[52:55], v[192:195]
  v_mfma_f32_16x16x32_bf16 v[196:199], a[120:123], a[52:55], v[196:199]
  v_mfma_f32_16x16x32_bf16 v[192:195], a[108:111], a[56:59], v[192:195]
  v_mfma_f32_16x16x32_bf16 v[196:199], a[124:127], a[56:59], v[196:199]
  v_mfma_f32_16x16x32_bf16 v[192:195], a[112:115], a[60:63], v[192:195]
  v_mfma_f32_16x16x32_bf16 v[196:199], a[128:131], a[60:63], v[196:199]
  s_nop 6
  v_max3_f32 v219, v192, v193, v219
  v_max3_f32 v219, v194, v195, v219
  v_max3_f32 v219, v196, v197, v219
  v_max3_f32 v219, v198, v199, v219
  v_mfma_f32_16x16x32_bf16 v[192:195], a[100:103], a[64:67], 0
  v_mfma_f32_16x16x32_bf16 v[196:199], a[116:119], a[64:67], 0
  v_mfma_f32_16x16x32_bf16 v[192:195], a[104:107], a[68:71], v[192:195]
  v_mfma_f32_16x16x32_bf16 v[196:199], a[120:123], a[68:71], v[196:199]
  v_mfma_f32_16x16x32_bf16 v[192:195], a[108:111], a[72:75], v[192:195]
  v_mfma_f32_16x16x32_bf16 v[196:199], a[124:127], a[72:75], v[196:199]
  v_mfma_f32_16x16x32_bf16 v[192:195], a[112:115], a[76:79], v[192:195]
  v_mfma_f32_16x16x32_bf16 v[196:199], a[128:131], a[76:79], v[196:199]
  s_nop 6
  v_max3_f32 v220, v192, v193, v220
  v_max3_f32 v220, v194, v195, v220
  v_max3_f32 v220, v196, v197, v220
  v_max3_f32 v220, v198, v199, v220
  s_waitcnt lgkmcnt(0)
  s_barrier
  s_add_u32 s32, s32, 8192
  s_add_u32 s30, s30, 1
  s_cmp_lt_u32 s30, 16
  s_cbranch_scc1 concat_heads__gqa_block_cached__mha_block_cached__near_ridge_kernel_mx
  v_xor_b32 v27, 16, v0
  v_lshlrev_b32 v27, 2, v27
  v_xor_b32 v28, 32, v0
  v_lshlrev_b32 v28, 2, v28
  ds_bpermute_b32 v192, v27, v216
  s_waitcnt lgkmcnt(0)
  v_max_f32 v216, v216, v192
  ds_bpermute_b32 v192, v28, v216
  s_waitcnt lgkmcnt(0)
  v_max_f32 v216, v216, v192
  v_sub_f32 v236, 0, v216
  v_sub_f32 v237, 0, v216
  v_sub_f32 v238, 0, v216
  v_sub_f32 v239, 0, v216
  ds_bpermute_b32 v192, v27, v217
  s_waitcnt lgkmcnt(0)
  v_max_f32 v217, v217, v192
  ds_bpermute_b32 v192, v28, v217
  s_waitcnt lgkmcnt(0)
  v_max_f32 v217, v217, v192
  v_sub_f32 v240, 0, v217
  v_sub_f32 v241, 0, v217
  v_sub_f32 v242, 0, v217
  v_sub_f32 v243, 0, v217
  ds_bpermute_b32 v192, v27, v218
  s_waitcnt lgkmcnt(0)
  v_max_f32 v218, v218, v192
  ds_bpermute_b32 v192, v28, v218
  s_waitcnt lgkmcnt(0)
  v_max_f32 v218, v218, v192
  v_sub_f32 v244, 0, v218
  v_sub_f32 v245, 0, v218
  v_sub_f32 v246, 0, v218
  v_sub_f32 v247, 0, v218
  ds_bpermute_b32 v192, v27, v219
  s_waitcnt lgkmcnt(0)
  v_max_f32 v219, v219, v192
  ds_bpermute_b32 v192, v28, v219
  s_waitcnt lgkmcnt(0)
  v_max_f32 v219, v219, v192
  v_sub_f32 v248, 0, v219
  v_sub_f32 v249, 0, v219
  v_sub_f32 v250, 0, v219
  v_sub_f32 v251, 0, v219
  ds_bpermute_b32 v192, v27, v220
  s_waitcnt lgkmcnt(0)
  v_max_f32 v220, v220, v192
  ds_bpermute_b32 v192, v28, v220
  s_waitcnt lgkmcnt(0)
  v_max_f32 v220, v220, v192
  v_sub_f32 v252, 0, v220
  v_sub_f32 v253, 0, v220
  v_sub_f32 v254, 0, v220
  v_sub_f32 v255, 0, v220
  v_add_u32 v5, 98304, v5
  v_add_u32 v6, 98304, v6
  v_add_u32 v7, 98304, v7
  v_add_u32 v8, 98304, v8
  v_add_u32 v9, 98304, v9
  v_add_u32 v10, 98304, v10
  v_add_u32 v11, 98304, v11
  v_add_u32 v12, 98304, v12
  v_add_u32 v13, 98304, v13
  v_add_u32 v14, 98304, v14
  v_add_u32 v15, 98304, v15
  v_add_u32 v16, 98304, v16
  s_add_u32 m0, s39, 114688
  s_add_u32 s37, s40, 0
  buffer_load_dwordx4 v1, s[12:15], s37 offen nt lds
  buffer_load_dwordx4 v2, s[12:15], s37 offen offset:1024 nt lds
  s_add_u32 m0, s39, 122880
  s_add_u32 s37, s40, 131072
  buffer_load_dwordx4 v1, s[12:15], s37 offen nt lds
  buffer_load_dwordx4 v2, s[12:15], s37 offen offset:1024 nt lds
  s_add_u32 m0, s39, 131072
  s_add_u32 s37, s40, 8192
  buffer_load_dwordx4 v1, s[12:15], s37 offen nt lds
  buffer_load_dwordx4 v2, s[12:15], s37 offen offset:1024 nt lds
  s_add_u32 m0, s39, 139264
  s_add_u32 s37, s40, 139264
  buffer_load_dwordx4 v1, s[12:15], s37 offen nt lds
  buffer_load_dwordx4 v2, s[12:15], s37 offen offset:1024 nt lds
  s_add_u32 m0, s39, 147456
  s_add_u32 s37, s40, 0
  buffer_load_dwordx4 v3, s[16:19], s37 offen nt lds
  buffer_load_dwordx4 v4, s[16:19], s37 offen offset:1024 nt lds
  s_add_u32 m0, s39, 155648
  s_add_u32 s37, s40, 131072
  buffer_load_dwordx4 v3, s[16:19], s37 offen nt lds
  buffer_load_dwordx4 v4, s[16:19], s37 offen offset:1024 nt lds
  s_add_u32 m0, s39, 0
  s_add_u32 s37, s40, 16384
  buffer_load_dwordx4 v1, s[12:15], s37 offen nt lds
  buffer_load_dwordx4 v2, s[12:15], s37 offen offset:1024 nt lds
  s_add_u32 m0, s39, 8192
  s_add_u32 s37, s40, 147456
  buffer_load_dwordx4 v1, s[12:15], s37 offen nt lds
  buffer_load_dwordx4 v2, s[12:15], s37 offen offset:1024 nt lds
  s_add_u32 m0, s39, 16384
  s_add_u32 s37, s40, 8192
  buffer_load_dwordx4 v3, s[16:19], s37 offen nt lds
  buffer_load_dwordx4 v4, s[16:19], s37 offen offset:1024 nt lds
  s_add_u32 m0, s39, 24576
  s_add_u32 s37, s40, 139264
  buffer_load_dwordx4 v3, s[16:19], s37 offen nt lds
  buffer_load_dwordx4 v4, s[16:19], s37 offen offset:1024 nt lds
  s_add_u32 m0, s39, 32768
  s_add_u32 s37, s40, 24576
  buffer_load_dwordx4 v1, s[12:15], s37 offen nt lds
  buffer_load_dwordx4 v2, s[12:15], s37 offen offset:1024 nt lds
  s_add_u32 m0, s39, 40960
  s_add_u32 s37, s40, 155648
  buffer_load_dwordx4 v1, s[12:15], s37 offen nt lds
  buffer_load_dwordx4 v2, s[12:15], s37 offen offset:1024 nt lds
  s_add_u32 m0, s39, 49152
  s_add_u32 s37, s40, 16384
  buffer_load_dwordx4 v3, s[16:19], s37 offen nt lds
  buffer_load_dwordx4 v4, s[16:19], s37 offen offset:1024 nt lds
  s_add_u32 m0, s39, 57344
  s_add_u32 s37, s40, 147456
  buffer_load_dwordx4 v3, s[16:19], s37 offen nt lds
  buffer_load_dwordx4 v4, s[16:19], s37 offen offset:1024 nt lds
  s_add_u32 m0, s39, 65536
  s_add_u32 s37, s40, 32768
  buffer_load_dwordx4 v1, s[12:15], s37 offen nt lds
  buffer_load_dwordx4 v2, s[12:15], s37 offen offset:1024 nt lds
  s_add_u32 m0, s39, 73728
  s_add_u32 s37, s40, 163840
  buffer_load_dwordx4 v1, s[12:15], s37 offen nt lds
  buffer_load_dwordx4 v2, s[12:15], s37 offen offset:1024 nt lds
  s_add_u32 m0, s39, 81920
  s_add_u32 s37, s40, 24576
  buffer_load_dwordx4 v3, s[16:19], s37 offen nt lds
  buffer_load_dwordx4 v4, s[16:19], s37 offen offset:1024 nt lds
  s_add_u32 m0, s39, 90112
  s_add_u32 s37, s40, 155648
  buffer_load_dwordx4 v3, s[16:19], s37 offen nt lds
  buffer_load_dwordx4 v4, s[16:19], s37 offen offset:1024 nt lds
  s_waitcnt vmcnt(0)
  s_barrier
  s_cmp_eq_u32 s24, 0
  s_cbranch_scc0 concat_heads__gqa_block_cached__mha_block_cached__near_ridge_kernel_k0p89
  ds_read_b128 a[100:103], v5 offset:16384
  ds_read_b128 a[104:107], v6 offset:16384
  ds_read_b128 a[108:111], v7 offset:16384
  ds_read_b128 a[112:115], v8 offset:16384
  ds_read_b128 a[116:119], v5 offset:20480
  ds_read_b128 a[120:123], v6 offset:20480
  ds_read_b128 a[124:127], v7 offset:20480
  ds_read_b128 a[128:131], v8 offset:20480
  s_branch concat_heads__gqa_block_cached__mha_block_cached__near_ridge_kernel_k0d90
concat_heads__gqa_block_cached__mha_block_cached__near_ridge_kernel_k0p89:
  ds_read_b128 a[132:135], v5 offset:16384
  ds_read_b128 a[136:139], v6 offset:16384
  ds_read_b128 a[140:143], v7 offset:16384
  ds_read_b128 a[144:147], v8 offset:16384
  ds_read_b128 a[148:151], v5 offset:20480
  ds_read_b128 a[152:155], v6 offset:20480
  ds_read_b128 a[156:159], v7 offset:20480
  s_waitcnt lgkmcnt(7)
  ds_read_b128 a[160:163], v8 offset:20480
concat_heads__gqa_block_cached__mha_block_cached__near_ridge_kernel_k0d90:
  s_waitcnt lgkmcnt(0)
  s_barrier
  s_add_u32 m0, s39, 98304
  s_add_u32 s37, s40, 40960
  buffer_load_dwordx4 v1, s[12:15], s37 offen nt lds
  buffer_load_dwordx4 v2, s[12:15], s37 offen offset:1024 nt lds
  s_add_u32 m0, s39, 106496
  s_add_u32 s37, s40, 172032
  buffer_load_dwordx4 v1, s[12:15], s37 offen nt lds
  buffer_load_dwordx4 v2, s[12:15], s37 offen offset:1024 nt lds
  s_add_u32 m0, s39, 114688
  s_add_u32 s37, s40, 32768
  buffer_load_dwordx4 v3, s[16:19], s37 offen nt lds
  buffer_load_dwordx4 v4, s[16:19], s37 offen offset:1024 nt lds
  s_add_u32 m0, s39, 122880
  s_add_u32 s37, s40, 163840
  buffer_load_dwordx4 v3, s[16:19], s37 offen nt lds
  buffer_load_dwordx4 v4, s[16:19], s37 offen offset:1024 nt lds
  s_branch concat_heads__gqa_block_cached__mha_block_cached__near_ridge_kernel_attn
concat_heads__gqa_block_cached__mha_block_cached__near_ridge_kernel_done:
  s_endpgm
.section .rodata,"a"
.p2align 6
.amdhsa_kernel concat_heads__gqa_block_cached__mha_block_cached__near_ridge_kernel
  .amdhsa_next_free_vgpr 512
  .amdhsa_next_free_sgpr 102
  .amdhsa_accum_offset 256
  .amdhsa_group_segment_fixed_size 0
  .amdhsa_kernarg_size 104
  .amdhsa_user_sgpr_count 2
  .amdhsa_user_sgpr_kernarg_segment_ptr 1
  .amdhsa_system_sgpr_workgroup_id_x 1
.end_amdhsa_kernel
.text
```
